```python
import torch

def _softmax(x, axis=-1):
    return torch.softmax(x, dim=axis)
def _gelu(x):
    return torch.nn.functional.gelu(x, approximate="tanh")
def _silu(x):
    return torch.nn.functional.silu(x)
def _sigmoid(x):
    return torch.sigmoid(x)
def _layernorm(x, axis=-1, eps=1e-5):
    m = x.mean(dim=axis, keepdim=True)
    v = x.var(dim=axis, keepdim=True, unbiased=False)
    return (x - m) / torch.sqrt(v + eps)
def _scatter_add(tgt, idx, src, axis=0):
    return tgt.clone().index_add_(axis, idx, src)
def _segment_sum(src, seg, n):
    out = torch.zeros((n,) + src.shape[1:], dtype=src.dtype)
    return out.index_add_(0, seg, src)
def _pad(x, pw):
    flat = tuple(v for pair in reversed(pw) for v in pair)
    return torch.nn.functional.pad(x, flat)

kernel_name = 'sequential_preLN__spectral_fnet__moe_arch_mod__prompt'

def setup_inputs():

    _w = (lambda a: (lambda t: t.to(torch.bfloat16) if t.is_floating_point() else t)(torch.as_tensor(a)))
    def _A_setup():
        B, S, D = 1, 2048, 640
        ns = torch.arange(S)[:, None] * torch.arange(S)[None, :]
        nd = torch.arange(D)[:, None] * torch.arange(D)[None, :]
        Ws_re = torch.cos(-2.0 * torch.pi * ns / S).to(float)
        Ws_im = torch.sin(-2.0 * torch.pi * ns / S).to(float)
        Wd_re = torch.cos(-2.0 * torch.pi * nd / D).to(float)
        Wd_im = torch.sin(-2.0 * torch.pi * nd / D).to(float)
        return {
            "x": _w((lambda *s: torch.randn(*s, dtype=torch.bfloat16) * 0.1)(B, S, D)),
            "dft_seq_re": _w(Ws_re),
            "dft_seq_im": _w(Ws_im),
            "dft_hid_re": _w(Wd_re),
            "dft_hid_im": _w(Wd_im),
        }
    _A_in = _A_setup()

    def _B_setup():
        B, S, D, F, C = 1, 2048, 640, 1536, 8
        return {
            "x": _w((lambda *s: torch.randn(*s, dtype=torch.bfloat16) * 0.1)(B, S, D)),
            "w_r": _w((lambda *s: torch.randn(*s, dtype=torch.bfloat16) * 1.6)(D)),
            "w_gate": _w((lambda *s: torch.randn(*s, dtype=torch.bfloat16) * 0.8)(D, F)),
            "w_up": _w((lambda *s: torch.randn(*s, dtype=torch.bfloat16) * 0.8)(D, F)),
            "w_down": _w((lambda *s: torch.randn(*s, dtype=torch.bfloat16) * 0.8)(F, D)),
        }
    _B_in = _B_setup()

    return {
        "A_x": _A_in["x"],
        "A_dft_seq_re": _A_in["dft_seq_re"],
        "A_dft_seq_im": _A_in["dft_seq_im"],
        "A_dft_hid_re": _A_in["dft_hid_re"],
        "A_dft_hid_im": _A_in["dft_hid_im"],
        "B_x": _B_in["x"],
        "B_w_r": _B_in["w_r"],
        "B_w_gate": _B_in["w_gate"],
        "B_w_up": _B_in["w_up"],
        "B_w_down": _B_in["w_down"],
    }

def reference(A_x, A_dft_seq_re, A_dft_seq_im, A_dft_hid_re, A_dft_hid_im, B_x, B_w_r, B_w_gate, B_w_up, B_w_down):
    def _A_ref(x, dft_seq_re, dft_seq_im, dft_hid_re, dft_hid_im):
        a = torch.einsum("bsd,ed->bse", x, dft_hid_re)
        b = torch.einsum("bsd,ed->bse", x, dft_hid_im)
        y = torch.einsum("ts,bse->bte", dft_seq_re, a) - torch.einsum("ts,bse->bte", dft_seq_im, b)
        return y

    def _B_ref(x, w_r, w_gate, w_up, w_down):
        B, S, D = x.shape
        C = 8
        r = x @ w_r
        idx = torch.argsort(-r, axis=-1)[:, :C]
        idx_e = (lambda x, n, axis: torch.repeat_interleave(x, n, dim=axis))(idx.reshape(B, C, 1), D, axis=2)
        x_sel = (lambda x, i, axis: torch.take_along_dim(x, i, dim=axis))(x, idx_e, axis=1)
        g = _silu(x_sel @ w_gate)
        u = x_sel @ w_up
        y = (g * u) @ w_down
        r_sel = _sigmoid((lambda x, i, axis: torch.take_along_dim(x, i, dim=axis))(r, idx, axis=1))
        y = y * r_sel.reshape(B, C, 1)
        b_off = (torch.arange(B) * S).reshape(B, 1)
        flat_idx = (idx + b_off).reshape(B * C)
        zero = (x * 0.0).reshape(B * S, D)
        upd = _scatter_add(zero, flat_idx, y.reshape(B * C, D), axis=0)
        return x + upd.reshape(B, S, D)

    x = A_x
    h = x + _A_ref(_layernorm(x, axis=-1), A_dft_seq_re, A_dft_seq_im, A_dft_hid_re, A_dft_hid_im)
    h2 = h + _B_ref(_layernorm(h, axis=-1), B_w_r, B_w_gate, B_w_up, B_w_down)
    return h2
```

```asm
; @launch kernel=gemm1_kernel grid=(256,1,1) block=(256,1,1) lds=131072
; @launch kernel=gemm2_kernel grid=(256,1,1) block=(256,1,1) lds=147456
; @launch kernel=ln2_kernel grid=(512,1,1) block=(256,1,1) lds=0
; @launch kernel=ffn1_kernel grid=(96,1,1) block=(256,1,1) lds=10304
; @launch kernel=ffn2_kernel grid=(20,1,1) block=(256,1,1) lds=0
.amdgcn_target "amdgcn-amd-amdhsa--gfx950"
.text
.globl gemm1_kernel
.p2align 8
.type gemm1_kernel,@function
gemm1_kernel:
    s_cmp_ge_u32 s2, 256
    s_cbranch_scc1 L_gemm1_kernel_end
    s_load_dwordx2 s[4:5], s[0:1], 96
    s_load_dwordx2 s[6:7], s[0:1], 0
    s_load_dwordx4 s[24:27], s[0:1], 24
    s_and_b32 s16, s2, 7
    s_lshr_b32 s17, s2, 3
    s_waitcnt lgkmcnt(0)
    s_mul_i32 s18, s17, 81920
    s_add_u32 s8, s6, s18
    s_addc_u32 s9, s7, 0
    s_sub_u32 s10, 2621440, s18
    s_mov_b32 s11, 0x00020000
    s_cmp_lt_u32 s16, 4
    s_cselect_b32 s12, s24, s26
    s_cselect_b32 s13, s25, s27
    s_and_b32 s18, s16, 3
    s_mul_i32 s18, s18, 204800
    s_add_u32 s12, s12, s18
    s_addc_u32 s13, s13, 0
    s_sub_u32 s14, 819200, s18
    s_mov_b32 s15, 0x00020000
    s_add_u32 s28, s4, 4194304
    s_addc_u32 s29, s5, 0
    s_mov_b32 s30, 5242880
    s_mov_b32 s31, 0x00020000
    v_lshrrev_b32 v13, 6, v0
    s_nop 0
    v_readfirstlane_b32 s32, v13
    s_lshl_b32 s33, s32, 10
    s_mul_i32 s34, s32, 5120
    s_mul_i32 s35, s32, 5120
    v_bfe_u32 v14, v0, 4, 2
    v_and_b32 v15, 15, v0
    v_lshrrev_b32 v16, 4, v0
    v_xor_b32 v15, v15, v16
    v_lshlrev_b32 v15, 4, v15
    s_mov_b32 s20, 1280
    s_mov_b32 s21, 1280
    v_mul_lo_u32 v1, v14, s20
    v_add_u32 v1, v1, v15
    v_mul_lo_u32 v2, v14, s21
    v_add_u32 v2, v2, v15
    v_and_b32 v14, 15, v0
    v_bfe_u32 v15, v0, 4, 2
    v_xor_b32 v15, v15, v14
    v_lshlrev_b32 v15, 4, v15
    v_lshrrev_b32 v16, 1, v13
    v_mul_u32_u24 v16, 32, v16
    v_add_u32 v16, v16, v14
    v_lshl_add_u32 v3, v16, 8, v15
    v_and_b32 v16, 1, v13
    v_mul_u32_u24 v16, 80, v16
    v_add_u32 v16, v16, v14
    v_lshl_add_u32 v4, v16, 8, v15
    v_add_u32 v4, 16384, v4
    v_mov_b32 v20, 0
    v_mov_b32 v21, 0
    v_mov_b32 v22, 0
    v_mov_b32 v23, 0
    v_mov_b32 v24, 0
    v_mov_b32 v25, 0
    v_mov_b32 v26, 0
    v_mov_b32 v27, 0
    v_mov_b32 v28, 0
    v_mov_b32 v29, 0
    v_mov_b32 v30, 0
    v_mov_b32 v31, 0
    v_mov_b32 v32, 0
    v_mov_b32 v33, 0
    v_mov_b32 v34, 0
    v_mov_b32 v35, 0
    v_mov_b32 v36, 0
    v_mov_b32 v37, 0
    v_mov_b32 v38, 0
    v_mov_b32 v39, 0
    v_mov_b32 v40, 0
    v_mov_b32 v41, 0
    v_mov_b32 v42, 0
    v_mov_b32 v43, 0
    v_mov_b32 v44, 0
    v_mov_b32 v45, 0
    v_mov_b32 v46, 0
    v_mov_b32 v47, 0
    v_mov_b32 v48, 0
    v_mov_b32 v49, 0
    v_mov_b32 v50, 0
    v_mov_b32 v51, 0
    v_mov_b32 v52, 0
    v_mov_b32 v53, 0
    v_mov_b32 v54, 0
    v_mov_b32 v55, 0
    v_mov_b32 v56, 0
    v_mov_b32 v57, 0
    v_mov_b32 v58, 0
    v_mov_b32 v59, 0
    v_mov_b32 v116, 0
    v_mov_b32 v117, 0
    v_mov_b32 v118, 0
    v_mov_b32 v119, 0
    v_mov_b32 v120, 0
    v_mov_b32 v121, 0
    v_mov_b32 v122, 0
    v_mov_b32 v123, 0
    v_mov_b32 v124, 0
    s_mov_b32 s42, 0x3f803f80
    s_mov_b32 s36, s33
    s_mov_b32 s37, 0
    s_mul_i32 s38, s2, 7
    s_lshr_b32 s22, s2, 4
    s_add_u32 s38, s38, s22
    s_mul_hi_u32 s22, s38, 858993460
    s_mul_i32 s22, s22, 5
    s_sub_u32 s38, s38, s22
    s_lshl_b32 s38, s38, 8
    s_add_u32 s40, s34, s38
    s_add_u32 s41, s35, s38
    s_mov_b32 s39, 0
L_gemm1_kernel_pro:
    s_add_u32 m0, s36, 0
    s_add_u32 s22, s40, 0
    buffer_load_dwordx4 v1, s[8:11], s22 offen lds
    s_add_u32 m0, s36, 4096
    s_add_u32 s22, s40, 20480
    buffer_load_dwordx4 v1, s[8:11], s22 offen lds
    s_add_u32 m0, s36, 8192
    s_add_u32 s22, s40, 40960
    buffer_load_dwordx4 v1, s[8:11], s22 offen lds
    s_add_u32 m0, s36, 12288
    s_add_u32 s22, s40, 61440
    buffer_load_dwordx4 v1, s[8:11], s22 offen lds
    s_add_u32 m0, s36, 16384
    s_add_u32 s22, s41, 0
    buffer_load_dwordx4 v2, s[12:15], s22 offen lds
    s_add_u32 m0, s36, 20480
    s_add_u32 s22, s41, 20480
    buffer_load_dwordx4 v2, s[12:15], s22 offen lds
    s_add_u32 m0, s36, 24576
    s_add_u32 s22, s41, 40960
    buffer_load_dwordx4 v2, s[12:15], s22 offen lds
    s_add_u32 m0, s36, 28672
    s_add_u32 s22, s41, 61440
    buffer_load_dwordx4 v2, s[12:15], s22 offen lds
    s_add_u32 m0, s36, 32768
    s_add_u32 s22, s41, 81920
    buffer_load_dwordx4 v2, s[12:15], s22 offen lds
    s_add_u32 m0, s36, 36864
    s_add_u32 s22, s41, 102400
    buffer_load_dwordx4 v2, s[12:15], s22 offen lds
    s_add_u32 m0, s36, 40960
    s_add_u32 s22, s41, 122880
    buffer_load_dwordx4 v2, s[12:15], s22 offen lds
    s_add_u32 m0, s36, 45056
    s_add_u32 s22, s41, 143360
    buffer_load_dwordx4 v2, s[12:15], s22 offen lds
    s_add_u32 m0, s36, 49152
    s_add_u32 s22, s41, 163840
    buffer_load_dwordx4 v2, s[12:15], s22 offen lds
    s_add_u32 m0, s36, 53248
    s_add_u32 s22, s41, 184320
    buffer_load_dwordx4 v2, s[12:15], s22 offen lds
    s_add_u32 s38, s38, 256
    s_cmp_ge_u32 s38, 1280
    s_cselect_b32 s38, 0, s38
    s_add_u32 s40, s34, s38
    s_add_u32 s41, s35, s38
    s_add_u32 s36, s36, 57344
    s_cmp_ge_u32 s36, 114688
    s_cselect_b32 s22, 114688, 0
    s_sub_u32 s36, s36, s22
    s_add_u32 s39, s39, 1
    s_cmp_lt_u32 s39, 1
    s_cbranch_scc1 L_gemm1_kernel_pro
    s_mov_b32 s39, 0
L_gemm1_kernel_loop:
    s_waitcnt vmcnt(0)
    s_barrier
    s_add_u32 m0, s36, 0
    s_add_u32 s22, s40, 0
    buffer_load_dwordx4 v1, s[8:11], s22 offen lds
    s_add_u32 m0, s36, 4096
    s_add_u32 s22, s40, 20480
    buffer_load_dwordx4 v1, s[8:11], s22 offen lds
    s_add_u32 m0, s36, 8192
    s_add_u32 s22, s40, 40960
    buffer_load_dwordx4 v1, s[8:11], s22 offen lds
    s_add_u32 m0, s36, 12288
    s_add_u32 s22, s40, 61440
    buffer_load_dwordx4 v1, s[8:11], s22 offen lds
    s_add_u32 m0, s36, 16384
    s_add_u32 s22, s41, 0
    buffer_load_dwordx4 v2, s[12:15], s22 offen lds
    s_add_u32 m0, s36, 20480
    s_add_u32 s22, s41, 20480
    buffer_load_dwordx4 v2, s[12:15], s22 offen lds
    s_add_u32 m0, s36, 24576
    s_add_u32 s22, s41, 40960
    buffer_load_dwordx4 v2, s[12:15], s22 offen lds
    s_add_u32 m0, s36, 28672
    s_add_u32 s22, s41, 61440
    buffer_load_dwordx4 v2, s[12:15], s22 offen lds
    s_add_u32 m0, s36, 32768
    s_add_u32 s22, s41, 81920
    buffer_load_dwordx4 v2, s[12:15], s22 offen lds
    s_add_u32 m0, s36, 36864
    s_add_u32 s22, s41, 102400
    buffer_load_dwordx4 v2, s[12:15], s22 offen lds
    s_add_u32 m0, s36, 40960
    s_add_u32 s22, s41, 122880
    buffer_load_dwordx4 v2, s[12:15], s22 offen lds
    s_add_u32 m0, s36, 45056
    s_add_u32 s22, s41, 143360
    buffer_load_dwordx4 v2, s[12:15], s22 offen lds
    s_add_u32 m0, s36, 49152
    s_add_u32 s22, s41, 163840
    buffer_load_dwordx4 v2, s[12:15], s22 offen lds
    s_add_u32 m0, s36, 53248
    s_add_u32 s22, s41, 184320
    buffer_load_dwordx4 v2, s[12:15], s22 offen lds
    s_add_u32 s38, s38, 256
    s_cmp_ge_u32 s38, 1280
    s_cselect_b32 s38, 0, s38
    s_add_u32 s40, s34, s38
    s_add_u32 s41, s35, s38
    s_add_u32 s36, s36, 57344
    s_cmp_ge_u32 s36, 114688
    s_cselect_b32 s22, 114688, 0
    s_sub_u32 s36, s36, s22
    v_add_u32 v5, s37, v3
    v_add_u32 v6, s37, v4
    v_add_u32 v7, s37, v3
    v_add_u32 v8, s37, v4
    v_xor_b32 v7, 64, v7
    v_xor_b32 v8, 64, v8
    v_add_u32 v9, s37, v3
    v_add_u32 v10, s37, v4
    v_xor_b32 v9, 128, v9
    v_xor_b32 v10, 128, v10
    v_add_u32 v11, s37, v3
    v_add_u32 v12, s37, v4
    v_xor_b32 v11, 192, v11
    v_xor_b32 v12, 192, v12
    s_add_u32 s37, s37, 57344
    s_cmp_ge_u32 s37, 114688
    s_cselect_b32 s22, 114688, 0
    s_sub_u32 s37, s37, s22
    ds_read_b128 v[60:63], v5 offset:0
    ds_read_b128 v[64:67], v5 offset:4096
    ds_read_b128 v[76:79], v6 offset:0
    ds_read_b128 v[80:83], v6 offset:4096
    ds_read_b128 v[84:87], v6 offset:8192
    ds_read_b128 v[88:91], v6 offset:12288
    ds_read_b128 v[92:95], v6 offset:16384
    ds_read_b128 v[68:71], v7 offset:0
    ds_read_b128 v[72:75], v7 offset:4096
    ds_read_b128 v[96:99], v8 offset:0
    ds_read_b128 v[100:103], v8 offset:4096
    ds_read_b128 v[104:107], v8 offset:8192
    ds_read_b128 v[108:111], v8 offset:12288
    ds_read_b128 v[112:115], v8 offset:16384
    s_waitcnt lgkmcnt(7)
    v_mfma_f32_16x16x32_bf16 v[20:23], v[60:63], v[76:79], v[20:23]
    v_mfma_f32_16x16x32_bf16 v[24:27], v[60:63], v[80:83], v[24:27]
    v_mfma_f32_16x16x32_bf16 v[28:31], v[60:63], v[84:87], v[28:31]
    v_mfma_f32_16x16x32_bf16 v[32:35], v[60:63], v[88:91], v[32:35]
    v_mfma_f32_16x16x32_bf16 v[36:39], v[60:63], v[92:95], v[36:39]
    v_mfma_f32_16x16x32_bf16 v[40:43], v[64:67], v[76:79], v[40:43]
    v_mfma_f32_16x16x32_bf16 v[44:47], v[64:67], v[80:83], v[44:47]
    v_mfma_f32_16x16x32_bf16 v[48:51], v[64:67], v[84:87], v[48:51]
    v_mfma_f32_16x16x32_bf16 v[52:55], v[64:67], v[88:91], v[52:55]
    v_mfma_f32_16x16x32_bf16 v[56:59], v[64:67], v[92:95], v[56:59]
    v_dot2_f32_bf16 v116, v60, s42, v116
    v_dot2_f32_bf16 v118, v60, v60, v118
    v_dot2_f32_bf16 v116, v61, s42, v116
    v_dot2_f32_bf16 v118, v61, v61, v118
    v_dot2_f32_bf16 v116, v62, s42, v116
    v_dot2_f32_bf16 v118, v62, v62, v118
    v_dot2_f32_bf16 v116, v63, s42, v116
    v_dot2_f32_bf16 v118, v63, v63, v118
    v_dot2_f32_bf16 v117, v64, s42, v117
    v_dot2_f32_bf16 v119, v64, v64, v119
    v_dot2_f32_bf16 v117, v65, s42, v117
    v_dot2_f32_bf16 v119, v65, v65, v119
    v_dot2_f32_bf16 v117, v66, s42, v117
    v_dot2_f32_bf16 v119, v66, v66, v119
    v_dot2_f32_bf16 v117, v67, s42, v117
    v_dot2_f32_bf16 v119, v67, v67, v119
    v_dot2_f32_bf16 v120, v76, s42, v120
    v_dot2_f32_bf16 v120, v77, s42, v120
    v_dot2_f32_bf16 v120, v78, s42, v120
    v_dot2_f32_bf16 v120, v79, s42, v120
    v_dot2_f32_bf16 v121, v80, s42, v121
    v_dot2_f32_bf16 v121, v81, s42, v121
    v_dot2_f32_bf16 v121, v82, s42, v121
    v_dot2_f32_bf16 v121, v83, s42, v121
    v_dot2_f32_bf16 v122, v84, s42, v122
    v_dot2_f32_bf16 v122, v85, s42, v122
    v_dot2_f32_bf16 v122, v86, s42, v122
    v_dot2_f32_bf16 v122, v87, s42, v122
    v_dot2_f32_bf16 v123, v88, s42, v123
    v_dot2_f32_bf16 v123, v89, s42, v123
    v_dot2_f32_bf16 v123, v90, s42, v123
    v_dot2_f32_bf16 v123, v91, s42, v123
    v_dot2_f32_bf16 v124, v92, s42, v124
    v_dot2_f32_bf16 v124, v93, s42, v124
    v_dot2_f32_bf16 v124, v94, s42, v124
    v_dot2_f32_bf16 v124, v95, s42, v124
    ds_read_b128 v[60:63], v9 offset:0
    ds_read_b128 v[64:67], v9 offset:4096
    ds_read_b128 v[76:79], v10 offset:0
    ds_read_b128 v[80:83], v10 offset:4096
    ds_read_b128 v[84:87], v10 offset:8192
    ds_read_b128 v[88:91], v10 offset:12288
    ds_read_b128 v[92:95], v10 offset:16384
    s_waitcnt lgkmcnt(7)
    v_mfma_f32_16x16x32_bf16 v[20:23], v[68:71], v[96:99], v[20:23]
    v_mfma_f32_16x16x32_bf16 v[24:27], v[68:71], v[100:103], v[24:27]
    v_mfma_f32_16x16x32_bf16 v[28:31], v[68:71], v[104:107], v[28:31]
    v_mfma_f32_16x16x32_bf16 v[32:35], v[68:71], v[108:111], v[32:35]
    v_mfma_f32_16x16x32_bf16 v[36:39], v[68:71], v[112:115], v[36:39]
    v_mfma_f32_16x16x32_bf16 v[40:43], v[72:75], v[96:99], v[40:43]
    v_mfma_f32_16x16x32_bf16 v[44:47], v[72:75], v[100:103], v[44:47]
    v_mfma_f32_16x16x32_bf16 v[48:51], v[72:75], v[104:107], v[48:51]
    v_mfma_f32_16x16x32_bf16 v[52:55], v[72:75], v[108:111], v[52:55]
    v_mfma_f32_16x16x32_bf16 v[56:59], v[72:75], v[112:115], v[56:59]
    v_dot2_f32_bf16 v116, v68, s42, v116
    v_dot2_f32_bf16 v118, v68, v68, v118
    v_dot2_f32_bf16 v116, v69, s42, v116
    v_dot2_f32_bf16 v118, v69, v69, v118
    v_dot2_f32_bf16 v116, v70, s42, v116
    v_dot2_f32_bf16 v118, v70, v70, v118
    v_dot2_f32_bf16 v116, v71, s42, v116
    v_dot2_f32_bf16 v118, v71, v71, v118
    v_dot2_f32_bf16 v117, v72, s42, v117
    v_dot2_f32_bf16 v119, v72, v72, v119
    v_dot2_f32_bf16 v117, v73, s42, v117
    v_dot2_f32_bf16 v119, v73, v73, v119
    v_dot2_f32_bf16 v117, v74, s42, v117
    v_dot2_f32_bf16 v119, v74, v74, v119
    v_dot2_f32_bf16 v117, v75, s42, v117
    v_dot2_f32_bf16 v119, v75, v75, v119
    v_dot2_f32_bf16 v120, v96, s42, v120
    v_dot2_f32_bf16 v120, v97, s42, v120
    v_dot2_f32_bf16 v120, v98, s42, v120
    v_dot2_f32_bf16 v120, v99, s42, v120
    v_dot2_f32_bf16 v121, v100, s42, v121
    v_dot2_f32_bf16 v121, v101, s42, v121
    v_dot2_f32_bf16 v121, v102, s42, v121
    v_dot2_f32_bf16 v121, v103, s42, v121
    v_dot2_f32_bf16 v122, v104, s42, v122
    v_dot2_f32_bf16 v122, v105, s42, v122
    v_dot2_f32_bf16 v122, v106, s42, v122
    v_dot2_f32_bf16 v122, v107, s42, v122
    v_dot2_f32_bf16 v123, v108, s42, v123
    v_dot2_f32_bf16 v123, v109, s42, v123
    v_dot2_f32_bf16 v123, v110, s42, v123
    v_dot2_f32_bf16 v123, v111, s42, v123
    v_dot2_f32_bf16 v124, v112, s42, v124
    v_dot2_f32_bf16 v124, v113, s42, v124
    v_dot2_f32_bf16 v124, v114, s42, v124
    v_dot2_f32_bf16 v124, v115, s42, v124
    ds_read_b128 v[68:71], v11 offset:0
    ds_read_b128 v[72:75], v11 offset:4096
    ds_read_b128 v[96:99], v12 offset:0
    ds_read_b128 v[100:103], v12 offset:4096
    ds_read_b128 v[104:107], v12 offset:8192
    ds_read_b128 v[108:111], v12 offset:12288
    ds_read_b128 v[112:115], v12 offset:16384
    s_waitcnt lgkmcnt(7)
    v_mfma_f32_16x16x32_bf16 v[20:23], v[60:63], v[76:79], v[20:23]
    v_mfma_f32_16x16x32_bf16 v[24:27], v[60:63], v[80:83], v[24:27]
    v_mfma_f32_16x16x32_bf16 v[28:31], v[60:63], v[84:87], v[28:31]
    v_mfma_f32_16x16x32_bf16 v[32:35], v[60:63], v[88:91], v[32:35]
    v_mfma_f32_16x16x32_bf16 v[36:39], v[60:63], v[92:95], v[36:39]
    v_mfma_f32_16x16x32_bf16 v[40:43], v[64:67], v[76:79], v[40:43]
    v_mfma_f32_16x16x32_bf16 v[44:47], v[64:67], v[80:83], v[44:47]
    v_mfma_f32_16x16x32_bf16 v[48:51], v[64:67], v[84:87], v[48:51]
    v_mfma_f32_16x16x32_bf16 v[52:55], v[64:67], v[88:91], v[52:55]
    v_mfma_f32_16x16x32_bf16 v[56:59], v[64:67], v[92:95], v[56:59]
    v_dot2_f32_bf16 v116, v60, s42, v116
    v_dot2_f32_bf16 v118, v60, v60, v118
    v_dot2_f32_bf16 v116, v61, s42, v116
    v_dot2_f32_bf16 v118, v61, v61, v118
    v_dot2_f32_bf16 v116, v62, s42, v116
    v_dot2_f32_bf16 v118, v62, v62, v118
    v_dot2_f32_bf16 v116, v63, s42, v116
    v_dot2_f32_bf16 v118, v63, v63, v118
    v_dot2_f32_bf16 v117, v64, s42, v117
    v_dot2_f32_bf16 v119, v64, v64, v119
    v_dot2_f32_bf16 v117, v65, s42, v117
    v_dot2_f32_bf16 v119, v65, v65, v119
    v_dot2_f32_bf16 v117, v66, s42, v117
    v_dot2_f32_bf16 v119, v66, v66, v119
    v_dot2_f32_bf16 v117, v67, s42, v117
    v_dot2_f32_bf16 v119, v67, v67, v119
    v_dot2_f32_bf16 v120, v76, s42, v120
    v_dot2_f32_bf16 v120, v77, s42, v120
    v_dot2_f32_bf16 v120, v78, s42, v120
    v_dot2_f32_bf16 v120, v79, s42, v120
    v_dot2_f32_bf16 v121, v80, s42, v121
    v_dot2_f32_bf16 v121, v81, s42, v121
    v_dot2_f32_bf16 v121, v82, s42, v121
    v_dot2_f32_bf16 v121, v83, s42, v121
    v_dot2_f32_bf16 v122, v84, s42, v122
    v_dot2_f32_bf16 v122, v85, s42, v122
    v_dot2_f32_bf16 v122, v86, s42, v122
    v_dot2_f32_bf16 v122, v87, s42, v122
    v_dot2_f32_bf16 v123, v88, s42, v123
    v_dot2_f32_bf16 v123, v89, s42, v123
    v_dot2_f32_bf16 v123, v90, s42, v123
    v_dot2_f32_bf16 v123, v91, s42, v123
    v_dot2_f32_bf16 v124, v92, s42, v124
    v_dot2_f32_bf16 v124, v93, s42, v124
    v_dot2_f32_bf16 v124, v94, s42, v124
    v_dot2_f32_bf16 v124, v95, s42, v124
    s_waitcnt lgkmcnt(0)
    v_mfma_f32_16x16x32_bf16 v[20:23], v[68:71], v[96:99], v[20:23]
    v_mfma_f32_16x16x32_bf16 v[24:27], v[68:71], v[100:103], v[24:27]
    v_mfma_f32_16x16x32_bf16 v[28:31], v[68:71], v[104:107], v[28:31]
    v_mfma_f32_16x16x32_bf16 v[32:35], v[68:71], v[108:111], v[32:35]
    v_mfma_f32_16x16x32_bf16 v[36:39], v[68:71], v[112:115], v[36:39]
    v_mfma_f32_16x16x32_bf16 v[40:43], v[72:75], v[96:99], v[40:43]
    v_mfma_f32_16x16x32_bf16 v[44:47], v[72:75], v[100:103], v[44:47]
    v_mfma_f32_16x16x32_bf16 v[48:51], v[72:75], v[104:107], v[48:51]
    v_mfma_f32_16x16x32_bf16 v[52:55], v[72:75], v[108:111], v[52:55]
    v_mfma_f32_16x16x32_bf16 v[56:59], v[72:75], v[112:115], v[56:59]
    v_dot2_f32_bf16 v116, v68, s42, v116
    v_dot2_f32_bf16 v118, v68, v68, v118
    v_dot2_f32_bf16 v116, v69, s42, v116
    v_dot2_f32_bf16 v118, v69, v69, v118
    v_dot2_f32_bf16 v116, v70, s42, v116
    v_dot2_f32_bf16 v118, v70, v70, v118
    v_dot2_f32_bf16 v116, v71, s42, v116
    v_dot2_f32_bf16 v118, v71, v71, v118
    v_dot2_f32_bf16 v117, v72, s42, v117
    v_dot2_f32_bf16 v119, v72, v72, v119
    v_dot2_f32_bf16 v117, v73, s42, v117
    v_dot2_f32_bf16 v119, v73, v73, v119
    v_dot2_f32_bf16 v117, v74, s42, v117
    v_dot2_f32_bf16 v119, v74, v74, v119
    v_dot2_f32_bf16 v117, v75, s42, v117
    v_dot2_f32_bf16 v119, v75, v75, v119
    v_dot2_f32_bf16 v120, v96, s42, v120
    v_dot2_f32_bf16 v120, v97, s42, v120
    v_dot2_f32_bf16 v120, v98, s42, v120
    v_dot2_f32_bf16 v120, v99, s42, v120
    v_dot2_f32_bf16 v121, v100, s42, v121
    v_dot2_f32_bf16 v121, v101, s42, v121
    v_dot2_f32_bf16 v121, v102, s42, v121
    v_dot2_f32_bf16 v121, v103, s42, v121
    v_dot2_f32_bf16 v122, v104, s42, v122
    v_dot2_f32_bf16 v122, v105, s42, v122
    v_dot2_f32_bf16 v122, v106, s42, v122
    v_dot2_f32_bf16 v122, v107, s42, v122
    v_dot2_f32_bf16 v123, v108, s42, v123
    v_dot2_f32_bf16 v123, v109, s42, v123
    v_dot2_f32_bf16 v123, v110, s42, v123
    v_dot2_f32_bf16 v123, v111, s42, v123
    v_dot2_f32_bf16 v124, v112, s42, v124
    v_dot2_f32_bf16 v124, v113, s42, v124
    v_dot2_f32_bf16 v124, v114, s42, v124
    v_dot2_f32_bf16 v124, v115, s42, v124
    s_add_u32 s39, s39, 1
    s_cmp_lt_u32 s39, 4
    s_cbranch_scc1 L_gemm1_kernel_loop
    s_waitcnt vmcnt(0)
    s_barrier
L_gemm1_kernel_tail:
    v_add_u32 v5, s37, v3
    v_add_u32 v6, s37, v4
    v_add_u32 v7, s37, v3
    v_add_u32 v8, s37, v4
    v_xor_b32 v7, 64, v7
    v_xor_b32 v8, 64, v8
    v_add_u32 v9, s37, v3
    v_add_u32 v10, s37, v4
    v_xor_b32 v9, 128, v9
    v_xor_b32 v10, 128, v10
    v_add_u32 v11, s37, v3
    v_add_u32 v12, s37, v4
    v_xor_b32 v11, 192, v11
    v_xor_b32 v12, 192, v12
    s_add_u32 s37, s37, 57344
    s_cmp_ge_u32 s37, 114688
    s_cselect_b32 s22, 114688, 0
    s_sub_u32 s37, s37, s22
    ds_read_b128 v[60:63], v5 offset:0
    ds_read_b128 v[64:67], v5 offset:4096
    ds_read_b128 v[76:79], v6 offset:0
    ds_read_b128 v[80:83], v6 offset:4096
    ds_read_b128 v[84:87], v6 offset:8192
    ds_read_b128 v[88:91], v6 offset:12288
    ds_read_b128 v[92:95], v6 offset:16384
    ds_read_b128 v[68:71], v7 offset:0
    ds_read_b128 v[72:75], v7 offset:4096
    ds_read_b128 v[96:99], v8 offset:0
    ds_read_b128 v[100:103], v8 offset:4096
    ds_read_b128 v[104:107], v8 offset:8192
    ds_read_b128 v[108:111], v8 offset:12288
    ds_read_b128 v[112:115], v8 offset:16384
    s_waitcnt lgkmcnt(7)
    v_mfma_f32_16x16x32_bf16 v[20:23], v[60:63], v[76:79], v[20:23]
    v_mfma_f32_16x16x32_bf16 v[24:27], v[60:63], v[80:83], v[24:27]
    v_mfma_f32_16x16x32_bf16 v[28:31], v[60:63], v[84:87], v[28:31]
    v_mfma_f32_16x16x32_bf16 v[32:35], v[60:63], v[88:91], v[32:35]
    v_mfma_f32_16x16x32_bf16 v[36:39], v[60:63], v[92:95], v[36:39]
    v_mfma_f32_16x16x32_bf16 v[40:43], v[64:67], v[76:79], v[40:43]
    v_mfma_f32_16x16x32_bf16 v[44:47], v[64:67], v[80:83], v[44:47]
    v_mfma_f32_16x16x32_bf16 v[48:51], v[64:67], v[84:87], v[48:51]
    v_mfma_f32_16x16x32_bf16 v[52:55], v[64:67], v[88:91], v[52:55]
    v_mfma_f32_16x16x32_bf16 v[56:59], v[64:67], v[92:95], v[56:59]
    v_dot2_f32_bf16 v116, v60, s42, v116
    v_dot2_f32_bf16 v118, v60, v60, v118
    v_dot2_f32_bf16 v116, v61, s42, v116
    v_dot2_f32_bf16 v118, v61, v61, v118
    v_dot2_f32_bf16 v116, v62, s42, v116
    v_dot2_f32_bf16 v118, v62, v62, v118
    v_dot2_f32_bf16 v116, v63, s42, v116
    v_dot2_f32_bf16 v118, v63, v63, v118
    v_dot2_f32_bf16 v117, v64, s42, v117
    v_dot2_f32_bf16 v119, v64, v64, v119
    v_dot2_f32_bf16 v117, v65, s42, v117
    v_dot2_f32_bf16 v119, v65, v65, v119
    v_dot2_f32_bf16 v117, v66, s42, v117
    v_dot2_f32_bf16 v119, v66, v66, v119
    v_dot2_f32_bf16 v117, v67, s42, v117
    v_dot2_f32_bf16 v119, v67, v67, v119
    v_dot2_f32_bf16 v120, v76, s42, v120
    v_dot2_f32_bf16 v120, v77, s42, v120
    v_dot2_f32_bf16 v120, v78, s42, v120
    v_dot2_f32_bf16 v120, v79, s42, v120
    v_dot2_f32_bf16 v121, v80, s42, v121
    v_dot2_f32_bf16 v121, v81, s42, v121
    v_dot2_f32_bf16 v121, v82, s42, v121
    v_dot2_f32_bf16 v121, v83, s42, v121
    v_dot2_f32_bf16 v122, v84, s42, v122
    v_dot2_f32_bf16 v122, v85, s42, v122
    v_dot2_f32_bf16 v122, v86, s42, v122
    v_dot2_f32_bf16 v122, v87, s42, v122
    v_dot2_f32_bf16 v123, v88, s42, v123
    v_dot2_f32_bf16 v123, v89, s42, v123
    v_dot2_f32_bf16 v123, v90, s42, v123
    v_dot2_f32_bf16 v123, v91, s42, v123
    v_dot2_f32_bf16 v124, v92, s42, v124
    v_dot2_f32_bf16 v124, v93, s42, v124
    v_dot2_f32_bf16 v124, v94, s42, v124
    v_dot2_f32_bf16 v124, v95, s42, v124
    ds_read_b128 v[60:63], v9 offset:0
    ds_read_b128 v[64:67], v9 offset:4096
    ds_read_b128 v[76:79], v10 offset:0
    ds_read_b128 v[80:83], v10 offset:4096
    ds_read_b128 v[84:87], v10 offset:8192
    ds_read_b128 v[88:91], v10 offset:12288
    ds_read_b128 v[92:95], v10 offset:16384
    s_waitcnt lgkmcnt(7)
    v_mfma_f32_16x16x32_bf16 v[20:23], v[68:71], v[96:99], v[20:23]
    v_mfma_f32_16x16x32_bf16 v[24:27], v[68:71], v[100:103], v[24:27]
    v_mfma_f32_16x16x32_bf16 v[28:31], v[68:71], v[104:107], v[28:31]
    v_mfma_f32_16x16x32_bf16 v[32:35], v[68:71], v[108:111], v[32:35]
    v_mfma_f32_16x16x32_bf16 v[36:39], v[68:71], v[112:115], v[36:39]
    v_mfma_f32_16x16x32_bf16 v[40:43], v[72:75], v[96:99], v[40:43]
    v_mfma_f32_16x16x32_bf16 v[44:47], v[72:75], v[100:103], v[44:47]
    v_mfma_f32_16x16x32_bf16 v[48:51], v[72:75], v[104:107], v[48:51]
    v_mfma_f32_16x16x32_bf16 v[52:55], v[72:75], v[108:111], v[52:55]
    v_mfma_f32_16x16x32_bf16 v[56:59], v[72:75], v[112:115], v[56:59]
    v_dot2_f32_bf16 v116, v68, s42, v116
    v_dot2_f32_bf16 v118, v68, v68, v118
    v_dot2_f32_bf16 v116, v69, s42, v116
    v_dot2_f32_bf16 v118, v69, v69, v118
    v_dot2_f32_bf16 v116, v70, s42, v116
    v_dot2_f32_bf16 v118, v70, v70, v118
    v_dot2_f32_bf16 v116, v71, s42, v116
    v_dot2_f32_bf16 v118, v71, v71, v118
    v_dot2_f32_bf16 v117, v72, s42, v117
    v_dot2_f32_bf16 v119, v72, v72, v119
    v_dot2_f32_bf16 v117, v73, s42, v117
    v_dot2_f32_bf16 v119, v73, v73, v119
    v_dot2_f32_bf16 v117, v74, s42, v117
    v_dot2_f32_bf16 v119, v74, v74, v119
    v_dot2_f32_bf16 v117, v75, s42, v117
    v_dot2_f32_bf16 v119, v75, v75, v119
    v_dot2_f32_bf16 v120, v96, s42, v120
    v_dot2_f32_bf16 v120, v97, s42, v120
    v_dot2_f32_bf16 v120, v98, s42, v120
    v_dot2_f32_bf16 v120, v99, s42, v120
    v_dot2_f32_bf16 v121, v100, s42, v121
    v_dot2_f32_bf16 v121, v101, s42, v121
    v_dot2_f32_bf16 v121, v102, s42, v121
    v_dot2_f32_bf16 v121, v103, s42, v121
    v_dot2_f32_bf16 v122, v104, s42, v122
    v_dot2_f32_bf16 v122, v105, s42, v122
    v_dot2_f32_bf16 v122, v106, s42, v122
    v_dot2_f32_bf16 v122, v107, s42, v122
    v_dot2_f32_bf16 v123, v108, s42, v123
    v_dot2_f32_bf16 v123, v109, s42, v123
    v_dot2_f32_bf16 v123, v110, s42, v123
    v_dot2_f32_bf16 v123, v111, s42, v123
    v_dot2_f32_bf16 v124, v112, s42, v124
    v_dot2_f32_bf16 v124, v113, s42, v124
    v_dot2_f32_bf16 v124, v114, s42, v124
    v_dot2_f32_bf16 v124, v115, s42, v124
    ds_read_b128 v[68:71], v11 offset:0
    ds_read_b128 v[72:75], v11 offset:4096
    ds_read_b128 v[96:99], v12 offset:0
    ds_read_b128 v[100:103], v12 offset:4096
    ds_read_b128 v[104:107], v12 offset:8192
    ds_read_b128 v[108:111], v12 offset:12288
    ds_read_b128 v[112:115], v12 offset:16384
    s_waitcnt lgkmcnt(7)
    v_mfma_f32_16x16x32_bf16 v[20:23], v[60:63], v[76:79], v[20:23]
    v_mfma_f32_16x16x32_bf16 v[24:27], v[60:63], v[80:83], v[24:27]
    v_mfma_f32_16x16x32_bf16 v[28:31], v[60:63], v[84:87], v[28:31]
    v_mfma_f32_16x16x32_bf16 v[32:35], v[60:63], v[88:91], v[32:35]
    v_mfma_f32_16x16x32_bf16 v[36:39], v[60:63], v[92:95], v[36:39]
    v_mfma_f32_16x16x32_bf16 v[40:43], v[64:67], v[76:79], v[40:43]
    v_mfma_f32_16x16x32_bf16 v[44:47], v[64:67], v[80:83], v[44:47]
    v_mfma_f32_16x16x32_bf16 v[48:51], v[64:67], v[84:87], v[48:51]
    v_mfma_f32_16x16x32_bf16 v[52:55], v[64:67], v[88:91], v[52:55]
    v_mfma_f32_16x16x32_bf16 v[56:59], v[64:67], v[92:95], v[56:59]
    v_dot2_f32_bf16 v116, v60, s42, v116
    v_dot2_f32_bf16 v118, v60, v60, v118
    v_dot2_f32_bf16 v116, v61, s42, v116
    v_dot2_f32_bf16 v118, v61, v61, v118
    v_dot2_f32_bf16 v116, v62, s42, v116
    v_dot2_f32_bf16 v118, v62, v62, v118
    v_dot2_f32_bf16 v116, v63, s42, v116
    v_dot2_f32_bf16 v118, v63, v63, v118
    v_dot2_f32_bf16 v117, v64, s42, v117
    v_dot2_f32_bf16 v119, v64, v64, v119
    v_dot2_f32_bf16 v117, v65, s42, v117
    v_dot2_f32_bf16 v119, v65, v65, v119
    v_dot2_f32_bf16 v117, v66, s42, v117
    v_dot2_f32_bf16 v119, v66, v66, v119
    v_dot2_f32_bf16 v117, v67, s42, v117
    v_dot2_f32_bf16 v119, v67, v67, v119
    v_dot2_f32_bf16 v120, v76, s42, v120
    v_dot2_f32_bf16 v120, v77, s42, v120
    v_dot2_f32_bf16 v120, v78, s42, v120
    v_dot2_f32_bf16 v120, v79, s42, v120
    v_dot2_f32_bf16 v121, v80, s42, v121
    v_dot2_f32_bf16 v121, v81, s42, v121
    v_dot2_f32_bf16 v121, v82, s42, v121
    v_dot2_f32_bf16 v121, v83, s42, v121
    v_dot2_f32_bf16 v122, v84, s42, v122
    v_dot2_f32_bf16 v122, v85, s42, v122
    v_dot2_f32_bf16 v122, v86, s42, v122
    v_dot2_f32_bf16 v122, v87, s42, v122
    v_dot2_f32_bf16 v123, v88, s42, v123
    v_dot2_f32_bf16 v123, v89, s42, v123
    v_dot2_f32_bf16 v123, v90, s42, v123
    v_dot2_f32_bf16 v123, v91, s42, v123
    v_dot2_f32_bf16 v124, v92, s42, v124
    v_dot2_f32_bf16 v124, v93, s42, v124
    v_dot2_f32_bf16 v124, v94, s42, v124
    v_dot2_f32_bf16 v124, v95, s42, v124
    s_waitcnt lgkmcnt(0)
    v_mfma_f32_16x16x32_bf16 v[20:23], v[68:71], v[96:99], v[20:23]
    v_mfma_f32_16x16x32_bf16 v[24:27], v[68:71], v[100:103], v[24:27]
    v_mfma_f32_16x16x32_bf16 v[28:31], v[68:71], v[104:107], v[28:31]
    v_mfma_f32_16x16x32_bf16 v[32:35], v[68:71], v[108:111], v[32:35]
    v_mfma_f32_16x16x32_bf16 v[36:39], v[68:71], v[112:115], v[36:39]
    v_mfma_f32_16x16x32_bf16 v[40:43], v[72:75], v[96:99], v[40:43]
    v_mfma_f32_16x16x32_bf16 v[44:47], v[72:75], v[100:103], v[44:47]
    v_mfma_f32_16x16x32_bf16 v[48:51], v[72:75], v[104:107], v[48:51]
    v_mfma_f32_16x16x32_bf16 v[52:55], v[72:75], v[108:111], v[52:55]
    v_mfma_f32_16x16x32_bf16 v[56:59], v[72:75], v[112:115], v[56:59]
    v_dot2_f32_bf16 v116, v68, s42, v116
    v_dot2_f32_bf16 v118, v68, v68, v118
    v_dot2_f32_bf16 v116, v69, s42, v116
    v_dot2_f32_bf16 v118, v69, v69, v118
    v_dot2_f32_bf16 v116, v70, s42, v116
    v_dot2_f32_bf16 v118, v70, v70, v118
    v_dot2_f32_bf16 v116, v71, s42, v116
    v_dot2_f32_bf16 v118, v71, v71, v118
    v_dot2_f32_bf16 v117, v72, s42, v117
    v_dot2_f32_bf16 v119, v72, v72, v119
    v_dot2_f32_bf16 v117, v73, s42, v117
    v_dot2_f32_bf16 v119, v73, v73, v119
    v_dot2_f32_bf16 v117, v74, s42, v117
    v_dot2_f32_bf16 v119, v74, v74, v119
    v_dot2_f32_bf16 v117, v75, s42, v117
    v_dot2_f32_bf16 v119, v75, v75, v119
    v_dot2_f32_bf16 v120, v96, s42, v120
    v_dot2_f32_bf16 v120, v97, s42, v120
    v_dot2_f32_bf16 v120, v98, s42, v120
    v_dot2_f32_bf16 v120, v99, s42, v120
    v_dot2_f32_bf16 v121, v100, s42, v121
    v_dot2_f32_bf16 v121, v101, s42, v121
    v_dot2_f32_bf16 v121, v102, s42, v121
    v_dot2_f32_bf16 v121, v103, s42, v121
    v_dot2_f32_bf16 v122, v104, s42, v122
    v_dot2_f32_bf16 v122, v105, s42, v122
    v_dot2_f32_bf16 v122, v106, s42, v122
    v_dot2_f32_bf16 v122, v107, s42, v122
    v_dot2_f32_bf16 v123, v108, s42, v123
    v_dot2_f32_bf16 v123, v109, s42, v123
    v_dot2_f32_bf16 v123, v110, s42, v123
    v_dot2_f32_bf16 v123, v111, s42, v123
    v_dot2_f32_bf16 v124, v112, s42, v124
    v_dot2_f32_bf16 v124, v113, s42, v124
    v_dot2_f32_bf16 v124, v114, s42, v124
    v_dot2_f32_bf16 v124, v115, s42, v124
    s_add_u32 s39, s39, 1
    s_cmp_lt_u32 s39, 5
    s_cbranch_scc1 L_gemm1_kernel_tail
    s_nop 7
    v_lshrrev_b32 v128, 6, v0
    v_lshlrev_b32 v128, 12, v128
    v_add_u32 v128, 114688, v128
    v_and_b32 v129, 63, v0
    v_lshl_add_u32 v129, v129, 2, v128
    v_and_b32 v130, 15, v0
    v_lshl_add_u32 v130, v130, 2, v128
    ds_write_b32 v129, v116 offset:0
    ds_write_b32 v129, v117 offset:256
    ds_write_b32 v129, v118 offset:512
    ds_write_b32 v129, v119 offset:768
    ds_write_b32 v129, v120 offset:1024
    ds_write_b32 v129, v121 offset:1280
    ds_write_b32 v129, v122 offset:1536
    ds_write_b32 v129, v123 offset:1792
    ds_write_b32 v129, v124 offset:2048
    s_waitcnt lgkmcnt(0)
    ds_read_b32 v132, v130 offset:0
    ds_read_b32 v133, v130 offset:64
    ds_read_b32 v134, v130 offset:128
    ds_read_b32 v135, v130 offset:192
    s_waitcnt lgkmcnt(0)
    v_add_f32 v116, v132, v133
    v_add_f32 v134, v134, v135
    v_add_f32 v116, v116, v134
    ds_read_b32 v132, v130 offset:256
    ds_read_b32 v133, v130 offset:320
    ds_read_b32 v134, v130 offset:384
    ds_read_b32 v135, v130 offset:448
    s_waitcnt lgkmcnt(0)
    v_add_f32 v117, v132, v133
    v_add_f32 v134, v134, v135
    v_add_f32 v117, v117, v134
    ds_read_b32 v132, v130 offset:512
    ds_read_b32 v133, v130 offset:576
    ds_read_b32 v134, v130 offset:640
    ds_read_b32 v135, v130 offset:704
    s_waitcnt lgkmcnt(0)
    v_add_f32 v118, v132, v133
    v_add_f32 v134, v134, v135
    v_add_f32 v118, v118, v134
    ds_read_b32 v132, v130 offset:768
    ds_read_b32 v133, v130 offset:832
    ds_read_b32 v134, v130 offset:896
    ds_read_b32 v135, v130 offset:960
    s_waitcnt lgkmcnt(0)
    v_add_f32 v119, v132, v133
    v_add_f32 v134, v134, v135
    v_add_f32 v119, v119, v134
    ds_read_b32 v132, v130 offset:1024
    ds_read_b32 v133, v130 offset:1088
    ds_read_b32 v134, v130 offset:1152
    ds_read_b32 v135, v130 offset:1216
    s_waitcnt lgkmcnt(0)
    v_add_f32 v120, v132, v133
    v_add_f32 v134, v134, v135
    v_add_f32 v120, v120, v134
    ds_read_b32 v132, v130 offset:1280
    ds_read_b32 v133, v130 offset:1344
    ds_read_b32 v134, v130 offset:1408
    ds_read_b32 v135, v130 offset:1472
    s_waitcnt lgkmcnt(0)
    v_add_f32 v121, v132, v133
    v_add_f32 v134, v134, v135
    v_add_f32 v121, v121, v134
    ds_read_b32 v132, v130 offset:1536
    ds_read_b32 v133, v130 offset:1600
    ds_read_b32 v134, v130 offset:1664
    ds_read_b32 v135, v130 offset:1728
    s_waitcnt lgkmcnt(0)
    v_add_f32 v122, v132, v133
    v_add_f32 v134, v134, v135
    v_add_f32 v122, v122, v134
    ds_read_b32 v132, v130 offset:1792
    ds_read_b32 v133, v130 offset:1856
    ds_read_b32 v134, v130 offset:1920
    ds_read_b32 v135, v130 offset:1984
    s_waitcnt lgkmcnt(0)
    v_add_f32 v123, v132, v133
    v_add_f32 v134, v134, v135
    v_add_f32 v123, v123, v134
    ds_read_b32 v132, v130 offset:2048
    ds_read_b32 v133, v130 offset:2112
    ds_read_b32 v134, v130 offset:2176
    ds_read_b32 v135, v130 offset:2240
    s_waitcnt lgkmcnt(0)
    v_add_f32 v124, v132, v133
    v_add_f32 v134, v134, v135
    v_add_f32 v124, v124, v134
    v_mul_f32 v116, 0.0015625, v116
    v_mul_f32 v118, 0.0015625, v118
    v_fma_f32 v118, -v116, v116, v118
    v_max_f32 v118, 0, v118
    v_cvt_pk_bf16_f32 v118, v118, v118
    v_lshlrev_b32 v118, 16, v118
    v_add_f32 v118, 0x3727c5ac, v118
    v_cvt_pk_bf16_f32 v118, v118, v118
    v_lshlrev_b32 v118, 16, v118
    v_sqrt_f32 v118, v118
    s_nop 0
    v_cvt_pk_bf16_f32 v118, v118, v118
    v_lshlrev_b32 v118, 16, v118
    v_rcp_f32 v118, v118
    v_cvt_pk_bf16_f32 v116, v116, v116
    v_lshlrev_b32 v116, 16, v116
    ds_write_b32 v130, v116 offset:3072
    ds_write_b32 v130, v118 offset:3136
    v_mul_f32 v117, 0.0015625, v117
    v_mul_f32 v119, 0.0015625, v119
    v_fma_f32 v119, -v117, v117, v119
    v_max_f32 v119, 0, v119
    v_cvt_pk_bf16_f32 v119, v119, v119
    v_lshlrev_b32 v119, 16, v119
    v_add_f32 v119, 0x3727c5ac, v119
    v_cvt_pk_bf16_f32 v119, v119, v119
    v_lshlrev_b32 v119, 16, v119
    v_sqrt_f32 v119, v119
    s_nop 0
    v_cvt_pk_bf16_f32 v119, v119, v119
    v_lshlrev_b32 v119, 16, v119
    v_rcp_f32 v119, v119
    v_cvt_pk_bf16_f32 v117, v117, v117
    v_lshlrev_b32 v117, 16, v117
    ds_write_b32 v130, v117 offset:3200
    ds_write_b32 v130, v119 offset:3264
    v_bfe_u32 v131, v0, 4, 2
    v_lshl_add_u32 v131, v131, 4, v128
    s_waitcnt lgkmcnt(0)
    ds_read_b128 v[132:135], v131 offset:3072
    ds_read_b128 v[136:139], v131 offset:3136
    s_waitcnt lgkmcnt(0)
    v_fma_f32 v20, -v132, v120, v20
    v_mul_f32 v20, v20, v136
    v_fma_f32 v21, -v133, v120, v21
    v_mul_f32 v21, v21, v137
    v_fma_f32 v22, -v134, v120, v22
    v_mul_f32 v22, v22, v138
    v_fma_f32 v23, -v135, v120, v23
    v_mul_f32 v23, v23, v139
    v_fma_f32 v24, -v132, v121, v24
    v_mul_f32 v24, v24, v136
    v_fma_f32 v25, -v133, v121, v25
    v_mul_f32 v25, v25, v137
    v_fma_f32 v26, -v134, v121, v26
    v_mul_f32 v26, v26, v138
    v_fma_f32 v27, -v135, v121, v27
    v_mul_f32 v27, v27, v139
    v_fma_f32 v28, -v132, v122, v28
    v_mul_f32 v28, v28, v136
    v_fma_f32 v29, -v133, v122, v29
    v_mul_f32 v29, v29, v137
    v_fma_f32 v30, -v134, v122, v30
    v_mul_f32 v30, v30, v138
    v_fma_f32 v31, -v135, v122, v31
    v_mul_f32 v31, v31, v139
    v_fma_f32 v32, -v132, v123, v32
    v_mul_f32 v32, v32, v136
    v_fma_f32 v33, -v133, v123, v33
    v_mul_f32 v33, v33, v137
    v_fma_f32 v34, -v134, v123, v34
    v_mul_f32 v34, v34, v138
    v_fma_f32 v35, -v135, v123, v35
    v_mul_f32 v35, v35, v139
    v_fma_f32 v36, -v132, v124, v36
    v_mul_f32 v36, v36, v136
    v_fma_f32 v37, -v133, v124, v37
    v_mul_f32 v37, v37, v137
    v_fma_f32 v38, -v134, v124, v38
    v_mul_f32 v38, v38, v138
    v_fma_f32 v39, -v135, v124, v39
    v_mul_f32 v39, v39, v139
    ds_read_b128 v[132:135], v131 offset:3200
    ds_read_b128 v[136:139], v131 offset:3264
    s_waitcnt lgkmcnt(0)
    v_fma_f32 v40, -v132, v120, v40
    v_mul_f32 v40, v40, v136
    v_fma_f32 v41, -v133, v120, v41
    v_mul_f32 v41, v41, v137
    v_fma_f32 v42, -v134, v120, v42
    v_mul_f32 v42, v42, v138
    v_fma_f32 v43, -v135, v120, v43
    v_mul_f32 v43, v43, v139
    v_fma_f32 v44, -v132, v121, v44
    v_mul_f32 v44, v44, v136
    v_fma_f32 v45, -v133, v121, v45
    v_mul_f32 v45, v45, v137
    v_fma_f32 v46, -v134, v121, v46
    v_mul_f32 v46, v46, v138
    v_fma_f32 v47, -v135, v121, v47
    v_mul_f32 v47, v47, v139
    v_fma_f32 v48, -v132, v122, v48
    v_mul_f32 v48, v48, v136
    v_fma_f32 v49, -v133, v122, v49
    v_mul_f32 v49, v49, v137
    v_fma_f32 v50, -v134, v122, v50
    v_mul_f32 v50, v50, v138
    v_fma_f32 v51, -v135, v122, v51
    v_mul_f32 v51, v51, v139
    v_fma_f32 v52, -v132, v123, v52
    v_mul_f32 v52, v52, v136
    v_fma_f32 v53, -v133, v123, v53
    v_mul_f32 v53, v53, v137
    v_fma_f32 v54, -v134, v123, v54
    v_mul_f32 v54, v54, v138
    v_fma_f32 v55, -v135, v123, v55
    v_mul_f32 v55, v55, v139
    v_fma_f32 v56, -v132, v124, v56
    v_mul_f32 v56, v56, v136
    v_fma_f32 v57, -v133, v124, v57
    v_mul_f32 v57, v57, v137
    v_fma_f32 v58, -v134, v124, v58
    v_mul_f32 v58, v58, v138
    v_fma_f32 v59, -v135, v124, v59
    v_mul_f32 v59, v59, v139
    v_lshrrev_b32 v13, 6, v0
    v_and_b32 v14, 15, v0
    v_and_b32 v15, 1, v13
    v_mul_u32_u24 v15, 80, v15
    v_add_u32 v14, v14, v15
    s_mul_i32 s18, s16, 160
    v_add_u32 v14, s18, v14
    v_lshlrev_b32 v14, 12, v14
    v_lshrrev_b32 v15, 1, v13
    v_lshlrev_b32 v15, 5, v15
    v_bfe_u32 v16, v0, 4, 2
    v_lshl_add_u32 v15, v16, 2, v15
    s_lshl_b32 s18, s17, 6
    v_add_u32 v15, s18, v15
    v_lshl_add_u32 v14, v15, 1, v14
    v_cvt_pk_bf16_f32 v20, v20, v21
    v_cvt_pk_bf16_f32 v21, v22, v23
    s_mov_b32 s18, 0
    buffer_store_dwordx2 v[20:21], v14, s[28:31], s18 offen
    v_cvt_pk_bf16_f32 v24, v24, v25
    v_cvt_pk_bf16_f32 v25, v26, v27
    s_mov_b32 s18, 65536
    buffer_store_dwordx2 v[24:25], v14, s[28:31], s18 offen
    v_cvt_pk_bf16_f32 v28, v28, v29
    v_cvt_pk_bf16_f32 v29, v30, v31
    s_mov_b32 s18, 131072
    buffer_store_dwordx2 v[28:29], v14, s[28:31], s18 offen
    v_cvt_pk_bf16_f32 v32, v32, v33
    v_cvt_pk_bf16_f32 v33, v34, v35
    s_mov_b32 s18, 196608
    buffer_store_dwordx2 v[32:33], v14, s[28:31], s18 offen
    v_cvt_pk_bf16_f32 v36, v36, v37
    v_cvt_pk_bf16_f32 v37, v38, v39
    s_mov_b32 s18, 262144
    buffer_store_dwordx2 v[36:37], v14, s[28:31], s18 offen
    v_cvt_pk_bf16_f32 v40, v40, v41
    v_cvt_pk_bf16_f32 v41, v42, v43
    s_mov_b32 s18, 32
    buffer_store_dwordx2 v[40:41], v14, s[28:31], s18 offen
    v_cvt_pk_bf16_f32 v44, v44, v45
    v_cvt_pk_bf16_f32 v45, v46, v47
    s_mov_b32 s18, 65568
    buffer_store_dwordx2 v[44:45], v14, s[28:31], s18 offen
    v_cvt_pk_bf16_f32 v48, v48, v49
    v_cvt_pk_bf16_f32 v49, v50, v51
    s_mov_b32 s18, 131104
    buffer_store_dwordx2 v[48:49], v14, s[28:31], s18 offen
    v_cvt_pk_bf16_f32 v52, v52, v53
    v_cvt_pk_bf16_f32 v53, v54, v55
    s_mov_b32 s18, 196640
    buffer_store_dwordx2 v[52:53], v14, s[28:31], s18 offen
    v_cvt_pk_bf16_f32 v56, v56, v57
    v_cvt_pk_bf16_f32 v57, v58, v59
    s_mov_b32 s18, 262176
    buffer_store_dwordx2 v[56:57], v14, s[28:31], s18 offen
L_gemm1_kernel_end:
    s_endpgm
.globl gemm2_kernel
.p2align 8
.type gemm2_kernel,@function
gemm2_kernel:
    s_cmp_ge_u32 s2, 256
    s_cbranch_scc1 L_gemm2_kernel_end
    s_load_dwordx2 s[4:5], s[0:1], 96
    s_load_dwordx4 s[24:27], s[0:1], 8
    s_and_b32 s16, s2, 3
    s_bfe_u32 s17, s2, 0x20003
    s_lshr_b32 s19, s2, 5
    s_bfe_u32 s18, s2, 0x10002
    s_lshl_b32 s18, s18, 3
    s_add_u32 s19, s19, s18
    s_waitcnt lgkmcnt(0)
    s_lshr_b32 s18, s16, 1
    s_mul_i32 s18, s18, 640
    s_mul_i32 s20, s17, 160
    s_add_u32 s18, s18, s20
    s_lshl_b32 s18, s18, 12
    s_and_b32 s20, s16, 1
    s_lshl_b32 s21, s20, 11
    s_add_u32 s18, s18, s21
    s_add_u32 s20, s18, 4194304
    s_add_u32 s8, s4, s20
    s_addc_u32 s9, s5, 0
    s_sub_u32 s10, 5242880, s18
    s_mov_b32 s11, 0x00020000
    s_cmp_lt_u32 s16, 2
    s_cselect_b32 s12, s24, s26
    s_cselect_b32 s13, s25, s27
    s_lshl_b32 s18, s19, 19
    s_add_u32 s18, s18, s21
    s_add_u32 s12, s12, s18
    s_addc_u32 s13, s13, 0
    s_sub_u32 s14, 8388608, s18
    s_mov_b32 s15, 0x00020000
    s_add_u32 s28, s4, 16777216
    s_addc_u32 s29, s5, 0
    s_mov_b32 s30, 10485760
    s_mov_b32 s31, 0x00020000
    v_lshrrev_b32 v13, 6, v0
    s_nop 0
    v_readfirstlane_b32 s32, v13
    s_lshl_b32 s33, s32, 10
    s_mul_i32 s34, s32, 16384
    s_mul_i32 s35, s32, 16384
    v_bfe_u32 v14, v0, 4, 2
    v_and_b32 v15, 15, v0
    v_lshrrev_b32 v16, 4, v0
    v_xor_b32 v15, v15, v16
    v_lshlrev_b32 v15, 4, v15
    s_mov_b32 s20, 4096
    s_mov_b32 s21, 4096
    v_mul_lo_u32 v1, v14, s20
    v_add_u32 v1, v1, v15
    v_mul_lo_u32 v2, v14, s21
    v_add_u32 v2, v2, v15
    v_and_b32 v14, 15, v0
    v_bfe_u32 v15, v0, 4, 2
    v_xor_b32 v15, v15, v14
    v_lshlrev_b32 v15, 4, v15
    v_lshrrev_b32 v16, 1, v13
    v_mul_u32_u24 v16, 80, v16
    v_add_u32 v16, v16, v14
    v_lshl_add_u32 v3, v16, 8, v15
    v_and_b32 v16, 1, v13
    v_mul_u32_u24 v16, 64, v16
    v_add_u32 v16, v16, v14
    v_lshl_add_u32 v4, v16, 8, v15
    v_add_u32 v4, 40960, v4
    v_mov_b32 v20, 0
    v_mov_b32 v21, 0
    v_mov_b32 v22, 0
    v_mov_b32 v23, 0
    v_mov_b32 v24, 0
    v_mov_b32 v25, 0
    v_mov_b32 v26, 0
    v_mov_b32 v27, 0
    v_mov_b32 v28, 0
    v_mov_b32 v29, 0
    v_mov_b32 v30, 0
    v_mov_b32 v31, 0
    v_mov_b32 v32, 0
    v_mov_b32 v33, 0
    v_mov_b32 v34, 0
    v_mov_b32 v35, 0
    v_mov_b32 v36, 0
    v_mov_b32 v37, 0
    v_mov_b32 v38, 0
    v_mov_b32 v39, 0
    v_mov_b32 v40, 0
    v_mov_b32 v41, 0
    v_mov_b32 v42, 0
    v_mov_b32 v43, 0
    v_mov_b32 v44, 0
    v_mov_b32 v45, 0
    v_mov_b32 v46, 0
    v_mov_b32 v47, 0
    v_mov_b32 v48, 0
    v_mov_b32 v49, 0
    v_mov_b32 v50, 0
    v_mov_b32 v51, 0
    v_mov_b32 v52, 0
    v_mov_b32 v53, 0
    v_mov_b32 v54, 0
    v_mov_b32 v55, 0
    v_mov_b32 v56, 0
    v_mov_b32 v57, 0
    v_mov_b32 v58, 0
    v_mov_b32 v59, 0
    v_mov_b32 v60, 0
    v_mov_b32 v61, 0
    v_mov_b32 v62, 0
    v_mov_b32 v63, 0
    v_mov_b32 v64, 0
    v_mov_b32 v65, 0
    v_mov_b32 v66, 0
    v_mov_b32 v67, 0
    v_mov_b32 v68, 0
    v_mov_b32 v69, 0
    v_mov_b32 v70, 0
    v_mov_b32 v71, 0
    v_mov_b32 v72, 0
    v_mov_b32 v73, 0
    v_mov_b32 v74, 0
    v_mov_b32 v75, 0
    v_mov_b32 v76, 0
    v_mov_b32 v77, 0
    v_mov_b32 v78, 0
    v_mov_b32 v79, 0
    v_mov_b32 v80, 0
    v_mov_b32 v81, 0
    v_mov_b32 v82, 0
    v_mov_b32 v83, 0
    v_mov_b32 v84, 0
    v_mov_b32 v85, 0
    v_mov_b32 v86, 0
    v_mov_b32 v87, 0
    v_mov_b32 v88, 0
    v_mov_b32 v89, 0
    v_mov_b32 v90, 0
    v_mov_b32 v91, 0
    v_mov_b32 v92, 0
    v_mov_b32 v93, 0
    v_mov_b32 v94, 0
    v_mov_b32 v95, 0
    v_mov_b32 v96, 0
    v_mov_b32 v97, 0
    v_mov_b32 v98, 0
    v_mov_b32 v99, 0
    s_mov_b32 s36, s33
    s_mov_b32 s37, 0
    s_mov_b32 s38, s19
    s_mul_hi_u32 s22, s38, 536870912
    s_mul_i32 s22, s22, 8
    s_sub_u32 s38, s38, s22
    s_lshl_b32 s38, s38, 8
    s_add_u32 s40, s34, s38
    s_add_u32 s41, s35, s38
    s_mov_b32 s39, 0
L_gemm2_kernel_pro:
    s_add_u32 m0, s36, 0
    s_add_u32 s22, s40, 0
    buffer_load_dwordx4 v1, s[8:11], s22 offen lds
    s_add_u32 m0, s36, 4096
    s_add_u32 s22, s40, 65536
    buffer_load_dwordx4 v1, s[8:11], s22 offen lds
    s_add_u32 m0, s36, 8192
    s_add_u32 s22, s40, 131072
    buffer_load_dwordx4 v1, s[8:11], s22 offen lds
    s_add_u32 m0, s36, 12288
    s_add_u32 s22, s40, 196608
    buffer_load_dwordx4 v1, s[8:11], s22 offen lds
    s_add_u32 m0, s36, 16384
    s_add_u32 s22, s40, 262144
    buffer_load_dwordx4 v1, s[8:11], s22 offen lds
    s_add_u32 m0, s36, 20480
    s_add_u32 s22, s40, 327680
    buffer_load_dwordx4 v1, s[8:11], s22 offen lds
    s_add_u32 m0, s36, 24576
    s_add_u32 s22, s40, 393216
    buffer_load_dwordx4 v1, s[8:11], s22 offen lds
    s_add_u32 m0, s36, 28672
    s_add_u32 s22, s40, 458752
    buffer_load_dwordx4 v1, s[8:11], s22 offen lds
    s_add_u32 m0, s36, 32768
    s_add_u32 s22, s40, 524288
    buffer_load_dwordx4 v1, s[8:11], s22 offen lds
    s_add_u32 m0, s36, 36864
    s_add_u32 s22, s40, 589824
    buffer_load_dwordx4 v1, s[8:11], s22 offen lds
    s_add_u32 m0, s36, 40960
    s_add_u32 s22, s41, 0
    buffer_load_dwordx4 v2, s[12:15], s22 offen lds
    s_add_u32 m0, s36, 45056
    s_add_u32 s22, s41, 65536
    buffer_load_dwordx4 v2, s[12:15], s22 offen lds
    s_add_u32 m0, s36, 49152
    s_add_u32 s22, s41, 131072
    buffer_load_dwordx4 v2, s[12:15], s22 offen lds
    s_add_u32 m0, s36, 53248
    s_add_u32 s22, s41, 196608
    buffer_load_dwordx4 v2, s[12:15], s22 offen lds
    s_add_u32 m0, s36, 57344
    s_add_u32 s22, s41, 262144
    buffer_load_dwordx4 v2, s[12:15], s22 offen lds
    s_add_u32 m0, s36, 61440
    s_add_u32 s22, s41, 327680
    buffer_load_dwordx4 v2, s[12:15], s22 offen lds
    s_add_u32 m0, s36, 65536
    s_add_u32 s22, s41, 393216
    buffer_load_dwordx4 v2, s[12:15], s22 offen lds
    s_add_u32 m0, s36, 69632
    s_add_u32 s22, s41, 458752
    buffer_load_dwordx4 v2, s[12:15], s22 offen lds
    s_add_u32 s38, s38, 256
    s_cmp_ge_u32 s38, 2048
    s_cselect_b32 s38, 0, s38
    s_add_u32 s40, s34, s38
    s_add_u32 s41, s35, s38
    s_add_u32 s36, s36, 73728
    s_cmp_ge_u32 s36, 147456
    s_cselect_b32 s22, 147456, 0
    s_sub_u32 s36, s36, s22
    s_add_u32 s39, s39, 1
    s_cmp_lt_u32 s39, 1
    s_cbranch_scc1 L_gemm2_kernel_pro
    s_mov_b32 s39, 0
L_gemm2_kernel_loop:
    s_waitcnt vmcnt(0)
    s_barrier
    s_add_u32 m0, s36, 0
    s_add_u32 s22, s40, 0
    buffer_load_dwordx4 v1, s[8:11], s22 offen lds
    s_add_u32 m0, s36, 4096
    s_add_u32 s22, s40, 65536
    buffer_load_dwordx4 v1, s[8:11], s22 offen lds
    s_add_u32 m0, s36, 8192
    s_add_u32 s22, s40, 131072
    buffer_load_dwordx4 v1, s[8:11], s22 offen lds
    s_add_u32 m0, s36, 12288
    s_add_u32 s22, s40, 196608
    buffer_load_dwordx4 v1, s[8:11], s22 offen lds
    s_add_u32 m0, s36, 16384
    s_add_u32 s22, s40, 262144
    buffer_load_dwordx4 v1, s[8:11], s22 offen lds
    s_add_u32 m0, s36, 20480
    s_add_u32 s22, s40, 327680
    buffer_load_dwordx4 v1, s[8:11], s22 offen lds
    s_add_u32 m0, s36, 24576
    s_add_u32 s22, s40, 393216
    buffer_load_dwordx4 v1, s[8:11], s22 offen lds
    s_add_u32 m0, s36, 28672
    s_add_u32 s22, s40, 458752
    buffer_load_dwordx4 v1, s[8:11], s22 offen lds
    s_add_u32 m0, s36, 32768
    s_add_u32 s22, s40, 524288
    buffer_load_dwordx4 v1, s[8:11], s22 offen lds
    s_add_u32 m0, s36, 36864
    s_add_u32 s22, s40, 589824
    buffer_load_dwordx4 v1, s[8:11], s22 offen lds
    s_add_u32 m0, s36, 40960
    s_add_u32 s22, s41, 0
    buffer_load_dwordx4 v2, s[12:15], s22 offen lds
    s_add_u32 m0, s36, 45056
    s_add_u32 s22, s41, 65536
    buffer_load_dwordx4 v2, s[12:15], s22 offen lds
    s_add_u32 m0, s36, 49152
    s_add_u32 s22, s41, 131072
    buffer_load_dwordx4 v2, s[12:15], s22 offen lds
    s_add_u32 m0, s36, 53248
    s_add_u32 s22, s41, 196608
    buffer_load_dwordx4 v2, s[12:15], s22 offen lds
    s_add_u32 m0, s36, 57344
    s_add_u32 s22, s41, 262144
    buffer_load_dwordx4 v2, s[12:15], s22 offen lds
    s_add_u32 m0, s36, 61440
    s_add_u32 s22, s41, 327680
    buffer_load_dwordx4 v2, s[12:15], s22 offen lds
    s_add_u32 m0, s36, 65536
    s_add_u32 s22, s41, 393216
    buffer_load_dwordx4 v2, s[12:15], s22 offen lds
    s_add_u32 m0, s36, 69632
    s_add_u32 s22, s41, 458752
    buffer_load_dwordx4 v2, s[12:15], s22 offen lds
    s_add_u32 s38, s38, 256
    s_cmp_ge_u32 s38, 2048
    s_cselect_b32 s38, 0, s38
    s_add_u32 s40, s34, s38
    s_add_u32 s41, s35, s38
    s_add_u32 s36, s36, 73728
    s_cmp_ge_u32 s36, 147456
    s_cselect_b32 s22, 147456, 0
    s_sub_u32 s36, s36, s22
    v_add_u32 v5, s37, v3
    v_add_u32 v6, s37, v4
    v_add_u32 v7, s37, v3
    v_add_u32 v8, s37, v4
    v_xor_b32 v7, 64, v7
    v_xor_b32 v8, 64, v8
    v_add_u32 v9, s37, v3
    v_add_u32 v10, s37, v4
    v_xor_b32 v9, 128, v9
    v_xor_b32 v10, 128, v10
    v_add_u32 v11, s37, v3
    v_add_u32 v12, s37, v4
    v_xor_b32 v11, 192, v11
    v_xor_b32 v12, 192, v12
    s_add_u32 s37, s37, 73728
    s_cmp_ge_u32 s37, 147456
    s_cselect_b32 s22, 147456, 0
    s_sub_u32 s37, s37, s22
    ds_read_b128 v[100:103], v5 offset:0
    ds_read_b128 v[104:107], v5 offset:4096
    ds_read_b128 v[108:111], v5 offset:8192
    ds_read_b128 v[112:115], v5 offset:12288
    ds_read_b128 v[116:119], v5 offset:16384
    ds_read_b128 v[140:143], v6 offset:0
    ds_read_b128 v[144:147], v6 offset:4096
    ds_read_b128 v[148:151], v6 offset:8192
    ds_read_b128 v[152:155], v6 offset:12288
    ds_read_b128 v[120:123], v7 offset:0
    ds_read_b128 v[124:127], v7 offset:4096
    ds_read_b128 v[128:131], v7 offset:8192
    ds_read_b128 v[132:135], v7 offset:12288
    ds_read_b128 v[136:139], v7 offset:16384
    ds_read_b128 v[156:159], v8 offset:0
    ds_read_b128 v[160:163], v8 offset:4096
    ds_read_b128 v[164:167], v8 offset:8192
    ds_read_b128 v[168:171], v8 offset:12288
    s_waitcnt lgkmcnt(9)
    v_mfma_f32_16x16x32_bf16 v[20:23], v[100:103], v[140:143], v[20:23]
    v_mfma_f32_16x16x32_bf16 v[24:27], v[100:103], v[144:147], v[24:27]
    v_mfma_f32_16x16x32_bf16 v[28:31], v[100:103], v[148:151], v[28:31]
    v_mfma_f32_16x16x32_bf16 v[32:35], v[100:103], v[152:155], v[32:35]
    v_mfma_f32_16x16x32_bf16 v[36:39], v[104:107], v[140:143], v[36:39]
    v_mfma_f32_16x16x32_bf16 v[40:43], v[104:107], v[144:147], v[40:43]
    v_mfma_f32_16x16x32_bf16 v[44:47], v[104:107], v[148:151], v[44:47]
    v_mfma_f32_16x16x32_bf16 v[48:51], v[104:107], v[152:155], v[48:51]
    v_mfma_f32_16x16x32_bf16 v[52:55], v[108:111], v[140:143], v[52:55]
    v_mfma_f32_16x16x32_bf16 v[56:59], v[108:111], v[144:147], v[56:59]
    v_mfma_f32_16x16x32_bf16 v[60:63], v[108:111], v[148:151], v[60:63]
    v_mfma_f32_16x16x32_bf16 v[64:67], v[108:111], v[152:155], v[64:67]
    v_mfma_f32_16x16x32_bf16 v[68:71], v[112:115], v[140:143], v[68:71]
    v_mfma_f32_16x16x32_bf16 v[72:75], v[112:115], v[144:147], v[72:75]
    v_mfma_f32_16x16x32_bf16 v[76:79], v[112:115], v[148:151], v[76:79]
    v_mfma_f32_16x16x32_bf16 v[80:83], v[112:115], v[152:155], v[80:83]
    v_mfma_f32_16x16x32_bf16 v[84:87], v[116:119], v[140:143], v[84:87]
    v_mfma_f32_16x16x32_bf16 v[88:91], v[116:119], v[144:147], v[88:91]
    v_mfma_f32_16x16x32_bf16 v[92:95], v[116:119], v[148:151], v[92:95]
    v_mfma_f32_16x16x32_bf16 v[96:99], v[116:119], v[152:155], v[96:99]
    ds_read_b128 v[100:103], v9 offset:0
    ds_read_b128 v[104:107], v9 offset:4096
    ds_read_b128 v[108:111], v9 offset:8192
    ds_read_b128 v[112:115], v9 offset:12288
    ds_read_b128 v[116:119], v9 offset:16384
    ds_read_b128 v[140:143], v10 offset:0
    ds_read_b128 v[144:147], v10 offset:4096
    ds_read_b128 v[148:151], v10 offset:8192
    ds_read_b128 v[152:155], v10 offset:12288
    s_waitcnt lgkmcnt(9)
    v_mfma_f32_16x16x32_bf16 v[20:23], v[120:123], v[156:159], v[20:23]
    v_mfma_f32_16x16x32_bf16 v[24:27], v[120:123], v[160:163], v[24:27]
    v_mfma_f32_16x16x32_bf16 v[28:31], v[120:123], v[164:167], v[28:31]
    v_mfma_f32_16x16x32_bf16 v[32:35], v[120:123], v[168:171], v[32:35]
    v_mfma_f32_16x16x32_bf16 v[36:39], v[124:127], v[156:159], v[36:39]
    v_mfma_f32_16x16x32_bf16 v[40:43], v[124:127], v[160:163], v[40:43]
    v_mfma_f32_16x16x32_bf16 v[44:47], v[124:127], v[164:167], v[44:47]
    v_mfma_f32_16x16x32_bf16 v[48:51], v[124:127], v[168:171], v[48:51]
    v_mfma_f32_16x16x32_bf16 v[52:55], v[128:131], v[156:159], v[52:55]
    v_mfma_f32_16x16x32_bf16 v[56:59], v[128:131], v[160:163], v[56:59]
    v_mfma_f32_16x16x32_bf16 v[60:63], v[128:131], v[164:167], v[60:63]
    v_mfma_f32_16x16x32_bf16 v[64:67], v[128:131], v[168:171], v[64:67]
    v_mfma_f32_16x16x32_bf16 v[68:71], v[132:135], v[156:159], v[68:71]
    v_mfma_f32_16x16x32_bf16 v[72:75], v[132:135], v[160:163], v[72:75]
    v_mfma_f32_16x16x32_bf16 v[76:79], v[132:135], v[164:167], v[76:79]
    v_mfma_f32_16x16x32_bf16 v[80:83], v[132:135], v[168:171], v[80:83]
    v_mfma_f32_16x16x32_bf16 v[84:87], v[136:139], v[156:159], v[84:87]
    v_mfma_f32_16x16x32_bf16 v[88:91], v[136:139], v[160:163], v[88:91]
    v_mfma_f32_16x16x32_bf16 v[92:95], v[136:139], v[164:167], v[92:95]
    v_mfma_f32_16x16x32_bf16 v[96:99], v[136:139], v[168:171], v[96:99]
    ds_read_b128 v[120:123], v11 offset:0
    ds_read_b128 v[124:127], v11 offset:4096
    ds_read_b128 v[128:131], v11 offset:8192
    ds_read_b128 v[132:135], v11 offset:12288
    ds_read_b128 v[136:139], v11 offset:16384
    ds_read_b128 v[156:159], v12 offset:0
    ds_read_b128 v[160:163], v12 offset:4096
    ds_read_b128 v[164:167], v12 offset:8192
    ds_read_b128 v[168:171], v12 offset:12288
    s_waitcnt lgkmcnt(9)
    v_mfma_f32_16x16x32_bf16 v[20:23], v[100:103], v[140:143], v[20:23]
    v_mfma_f32_16x16x32_bf16 v[24:27], v[100:103], v[144:147], v[24:27]
    v_mfma_f32_16x16x32_bf16 v[28:31], v[100:103], v[148:151], v[28:31]
    v_mfma_f32_16x16x32_bf16 v[32:35], v[100:103], v[152:155], v[32:35]
    v_mfma_f32_16x16x32_bf16 v[36:39], v[104:107], v[140:143], v[36:39]
    v_mfma_f32_16x16x32_bf16 v[40:43], v[104:107], v[144:147], v[40:43]
    v_mfma_f32_16x16x32_bf16 v[44:47], v[104:107], v[148:151], v[44:47]
    v_mfma_f32_16x16x32_bf16 v[48:51], v[104:107], v[152:155], v[48:51]
    v_mfma_f32_16x16x32_bf16 v[52:55], v[108:111], v[140:143], v[52:55]
    v_mfma_f32_16x16x32_bf16 v[56:59], v[108:111], v[144:147], v[56:59]
    v_mfma_f32_16x16x32_bf16 v[60:63], v[108:111], v[148:151], v[60:63]
    v_mfma_f32_16x16x32_bf16 v[64:67], v[108:111], v[152:155], v[64:67]
    v_mfma_f32_16x16x32_bf16 v[68:71], v[112:115], v[140:143], v[68:71]
    v_mfma_f32_16x16x32_bf16 v[72:75], v[112:115], v[144:147], v[72:75]
    v_mfma_f32_16x16x32_bf16 v[76:79], v[112:115], v[148:151], v[76:79]
    v_mfma_f32_16x16x32_bf16 v[80:83], v[112:115], v[152:155], v[80:83]
    v_mfma_f32_16x16x32_bf16 v[84:87], v[116:119], v[140:143], v[84:87]
    v_mfma_f32_16x16x32_bf16 v[88:91], v[116:119], v[144:147], v[88:91]
    v_mfma_f32_16x16x32_bf16 v[92:95], v[116:119], v[148:151], v[92:95]
    v_mfma_f32_16x16x32_bf16 v[96:99], v[116:119], v[152:155], v[96:99]
    s_waitcnt lgkmcnt(0)
    v_mfma_f32_16x16x32_bf16 v[20:23], v[120:123], v[156:159], v[20:23]
    v_mfma_f32_16x16x32_bf16 v[24:27], v[120:123], v[160:163], v[24:27]
    v_mfma_f32_16x16x32_bf16 v[28:31], v[120:123], v[164:167], v[28:31]
    v_mfma_f32_16x16x32_bf16 v[32:35], v[120:123], v[168:171], v[32:35]
    v_mfma_f32_16x16x32_bf16 v[36:39], v[124:127], v[156:159], v[36:39]
    v_mfma_f32_16x16x32_bf16 v[40:43], v[124:127], v[160:163], v[40:43]
    v_mfma_f32_16x16x32_bf16 v[44:47], v[124:127], v[164:167], v[44:47]
    v_mfma_f32_16x16x32_bf16 v[48:51], v[124:127], v[168:171], v[48:51]
    v_mfma_f32_16x16x32_bf16 v[52:55], v[128:131], v[156:159], v[52:55]
    v_mfma_f32_16x16x32_bf16 v[56:59], v[128:131], v[160:163], v[56:59]
    v_mfma_f32_16x16x32_bf16 v[60:63], v[128:131], v[164:167], v[60:63]
    v_mfma_f32_16x16x32_bf16 v[64:67], v[128:131], v[168:171], v[64:67]
    v_mfma_f32_16x16x32_bf16 v[68:71], v[132:135], v[156:159], v[68:71]
    v_mfma_f32_16x16x32_bf16 v[72:75], v[132:135], v[160:163], v[72:75]
    v_mfma_f32_16x16x32_bf16 v[76:79], v[132:135], v[164:167], v[76:79]
    v_mfma_f32_16x16x32_bf16 v[80:83], v[132:135], v[168:171], v[80:83]
    v_mfma_f32_16x16x32_bf16 v[84:87], v[136:139], v[156:159], v[84:87]
    v_mfma_f32_16x16x32_bf16 v[88:91], v[136:139], v[160:163], v[88:91]
    v_mfma_f32_16x16x32_bf16 v[92:95], v[136:139], v[164:167], v[92:95]
    v_mfma_f32_16x16x32_bf16 v[96:99], v[136:139], v[168:171], v[96:99]
    s_add_u32 s39, s39, 1
    s_cmp_lt_u32 s39, 7
    s_cbranch_scc1 L_gemm2_kernel_loop
    s_waitcnt vmcnt(0)
    s_barrier
L_gemm2_kernel_tail:
    v_add_u32 v5, s37, v3
    v_add_u32 v6, s37, v4
    v_add_u32 v7, s37, v3
    v_add_u32 v8, s37, v4
    v_xor_b32 v7, 64, v7
    v_xor_b32 v8, 64, v8
    v_add_u32 v9, s37, v3
    v_add_u32 v10, s37, v4
    v_xor_b32 v9, 128, v9
    v_xor_b32 v10, 128, v10
    v_add_u32 v11, s37, v3
    v_add_u32 v12, s37, v4
    v_xor_b32 v11, 192, v11
    v_xor_b32 v12, 192, v12
    s_add_u32 s37, s37, 73728
    s_cmp_ge_u32 s37, 147456
    s_cselect_b32 s22, 147456, 0
    s_sub_u32 s37, s37, s22
    ds_read_b128 v[100:103], v5 offset:0
    ds_read_b128 v[104:107], v5 offset:4096
    ds_read_b128 v[108:111], v5 offset:8192
    ds_read_b128 v[112:115], v5 offset:12288
    ds_read_b128 v[116:119], v5 offset:16384
    ds_read_b128 v[140:143], v6 offset:0
    ds_read_b128 v[144:147], v6 offset:4096
    ds_read_b128 v[148:151], v6 offset:8192
    ds_read_b128 v[152:155], v6 offset:12288
    ds_read_b128 v[120:123], v7 offset:0
    ds_read_b128 v[124:127], v7 offset:4096
    ds_read_b128 v[128:131], v7 offset:8192
    ds_read_b128 v[132:135], v7 offset:12288
    ds_read_b128 v[136:139], v7 offset:16384
    ds_read_b128 v[156:159], v8 offset:0
    ds_read_b128 v[160:163], v8 offset:4096
    ds_read_b128 v[164:167], v8 offset:8192
    ds_read_b128 v[168:171], v8 offset:12288
    s_waitcnt lgkmcnt(9)
    v_mfma_f32_16x16x32_bf16 v[20:23], v[100:103], v[140:143], v[20:23]
    v_mfma_f32_16x16x32_bf16 v[24:27], v[100:103], v[144:147], v[24:27]
    v_mfma_f32_16x16x32_bf16 v[28:31], v[100:103], v[148:151], v[28:31]
    v_mfma_f32_16x16x32_bf16 v[32:35], v[100:103], v[152:155], v[32:35]
    v_mfma_f32_16x16x32_bf16 v[36:39], v[104:107], v[140:143], v[36:39]
    v_mfma_f32_16x16x32_bf16 v[40:43], v[104:107], v[144:147], v[40:43]
    v_mfma_f32_16x16x32_bf16 v[44:47], v[104:107], v[148:151], v[44:47]
    v_mfma_f32_16x16x32_bf16 v[48:51], v[104:107], v[152:155], v[48:51]
    v_mfma_f32_16x16x32_bf16 v[52:55], v[108:111], v[140:143], v[52:55]
    v_mfma_f32_16x16x32_bf16 v[56:59], v[108:111], v[144:147], v[56:59]
    v_mfma_f32_16x16x32_bf16 v[60:63], v[108:111], v[148:151], v[60:63]
    v_mfma_f32_16x16x32_bf16 v[64:67], v[108:111], v[152:155], v[64:67]
    v_mfma_f32_16x16x32_bf16 v[68:71], v[112:115], v[140:143], v[68:71]
    v_mfma_f32_16x16x32_bf16 v[72:75], v[112:115], v[144:147], v[72:75]
    v_mfma_f32_16x16x32_bf16 v[76:79], v[112:115], v[148:151], v[76:79]
    v_mfma_f32_16x16x32_bf16 v[80:83], v[112:115], v[152:155], v[80:83]
    v_mfma_f32_16x16x32_bf16 v[84:87], v[116:119], v[140:143], v[84:87]
    v_mfma_f32_16x16x32_bf16 v[88:91], v[116:119], v[144:147], v[88:91]
    v_mfma_f32_16x16x32_bf16 v[92:95], v[116:119], v[148:151], v[92:95]
    v_mfma_f32_16x16x32_bf16 v[96:99], v[116:119], v[152:155], v[96:99]
    ds_read_b128 v[100:103], v9 offset:0
    ds_read_b128 v[104:107], v9 offset:4096
    ds_read_b128 v[108:111], v9 offset:8192
    ds_read_b128 v[112:115], v9 offset:12288
    ds_read_b128 v[116:119], v9 offset:16384
    ds_read_b128 v[140:143], v10 offset:0
    ds_read_b128 v[144:147], v10 offset:4096
    ds_read_b128 v[148:151], v10 offset:8192
    ds_read_b128 v[152:155], v10 offset:12288
    s_waitcnt lgkmcnt(9)
    v_mfma_f32_16x16x32_bf16 v[20:23], v[120:123], v[156:159], v[20:23]
    v_mfma_f32_16x16x32_bf16 v[24:27], v[120:123], v[160:163], v[24:27]
    v_mfma_f32_16x16x32_bf16 v[28:31], v[120:123], v[164:167], v[28:31]
    v_mfma_f32_16x16x32_bf16 v[32:35], v[120:123], v[168:171], v[32:35]
    v_mfma_f32_16x16x32_bf16 v[36:39], v[124:127], v[156:159], v[36:39]
    v_mfma_f32_16x16x32_bf16 v[40:43], v[124:127], v[160:163], v[40:43]
    v_mfma_f32_16x16x32_bf16 v[44:47], v[124:127], v[164:167], v[44:47]
    v_mfma_f32_16x16x32_bf16 v[48:51], v[124:127], v[168:171], v[48:51]
    v_mfma_f32_16x16x32_bf16 v[52:55], v[128:131], v[156:159], v[52:55]
    v_mfma_f32_16x16x32_bf16 v[56:59], v[128:131], v[160:163], v[56:59]
    v_mfma_f32_16x16x32_bf16 v[60:63], v[128:131], v[164:167], v[60:63]
    v_mfma_f32_16x16x32_bf16 v[64:67], v[128:131], v[168:171], v[64:67]
    v_mfma_f32_16x16x32_bf16 v[68:71], v[132:135], v[156:159], v[68:71]
    v_mfma_f32_16x16x32_bf16 v[72:75], v[132:135], v[160:163], v[72:75]
    v_mfma_f32_16x16x32_bf16 v[76:79], v[132:135], v[164:167], v[76:79]
    v_mfma_f32_16x16x32_bf16 v[80:83], v[132:135], v[168:171], v[80:83]
    v_mfma_f32_16x16x32_bf16 v[84:87], v[136:139], v[156:159], v[84:87]
    v_mfma_f32_16x16x32_bf16 v[88:91], v[136:139], v[160:163], v[88:91]
    v_mfma_f32_16x16x32_bf16 v[92:95], v[136:139], v[164:167], v[92:95]
    v_mfma_f32_16x16x32_bf16 v[96:99], v[136:139], v[168:171], v[96:99]
    ds_read_b128 v[120:123], v11 offset:0
    ds_read_b128 v[124:127], v11 offset:4096
    ds_read_b128 v[128:131], v11 offset:8192
    ds_read_b128 v[132:135], v11 offset:12288
    ds_read_b128 v[136:139], v11 offset:16384
    ds_read_b128 v[156:159], v12 offset:0
    ds_read_b128 v[160:163], v12 offset:4096
    ds_read_b128 v[164:167], v12 offset:8192
    ds_read_b128 v[168:171], v12 offset:12288
    s_waitcnt lgkmcnt(9)
    v_mfma_f32_16x16x32_bf16 v[20:23], v[100:103], v[140:143], v[20:23]
    v_mfma_f32_16x16x32_bf16 v[24:27], v[100:103], v[144:147], v[24:27]
    v_mfma_f32_16x16x32_bf16 v[28:31], v[100:103], v[148:151], v[28:31]
    v_mfma_f32_16x16x32_bf16 v[32:35], v[100:103], v[152:155], v[32:35]
    v_mfma_f32_16x16x32_bf16 v[36:39], v[104:107], v[140:143], v[36:39]
    v_mfma_f32_16x16x32_bf16 v[40:43], v[104:107], v[144:147], v[40:43]
    v_mfma_f32_16x16x32_bf16 v[44:47], v[104:107], v[148:151], v[44:47]
    v_mfma_f32_16x16x32_bf16 v[48:51], v[104:107], v[152:155], v[48:51]
    v_mfma_f32_16x16x32_bf16 v[52:55], v[108:111], v[140:143], v[52:55]
    v_mfma_f32_16x16x32_bf16 v[56:59], v[108:111], v[144:147], v[56:59]
    v_mfma_f32_16x16x32_bf16 v[60:63], v[108:111], v[148:151], v[60:63]
    v_mfma_f32_16x16x32_bf16 v[64:67], v[108:111], v[152:155], v[64:67]
    v_mfma_f32_16x16x32_bf16 v[68:71], v[112:115], v[140:143], v[68:71]
    v_mfma_f32_16x16x32_bf16 v[72:75], v[112:115], v[144:147], v[72:75]
    v_mfma_f32_16x16x32_bf16 v[76:79], v[112:115], v[148:151], v[76:79]
    v_mfma_f32_16x16x32_bf16 v[80:83], v[112:115], v[152:155], v[80:83]
    v_mfma_f32_16x16x32_bf16 v[84:87], v[116:119], v[140:143], v[84:87]
    v_mfma_f32_16x16x32_bf16 v[88:91], v[116:119], v[144:147], v[88:91]
    v_mfma_f32_16x16x32_bf16 v[92:95], v[116:119], v[148:151], v[92:95]
    v_mfma_f32_16x16x32_bf16 v[96:99], v[116:119], v[152:155], v[96:99]
    s_waitcnt lgkmcnt(0)
    v_mfma_f32_16x16x32_bf16 v[20:23], v[120:123], v[156:159], v[20:23]
    v_mfma_f32_16x16x32_bf16 v[24:27], v[120:123], v[160:163], v[24:27]
    v_mfma_f32_16x16x32_bf16 v[28:31], v[120:123], v[164:167], v[28:31]
    v_mfma_f32_16x16x32_bf16 v[32:35], v[120:123], v[168:171], v[32:35]
    v_mfma_f32_16x16x32_bf16 v[36:39], v[124:127], v[156:159], v[36:39]
    v_mfma_f32_16x16x32_bf16 v[40:43], v[124:127], v[160:163], v[40:43]
    v_mfma_f32_16x16x32_bf16 v[44:47], v[124:127], v[164:167], v[44:47]
    v_mfma_f32_16x16x32_bf16 v[48:51], v[124:127], v[168:171], v[48:51]
    v_mfma_f32_16x16x32_bf16 v[52:55], v[128:131], v[156:159], v[52:55]
    v_mfma_f32_16x16x32_bf16 v[56:59], v[128:131], v[160:163], v[56:59]
    v_mfma_f32_16x16x32_bf16 v[60:63], v[128:131], v[164:167], v[60:63]
    v_mfma_f32_16x16x32_bf16 v[64:67], v[128:131], v[168:171], v[64:67]
    v_mfma_f32_16x16x32_bf16 v[68:71], v[132:135], v[156:159], v[68:71]
    v_mfma_f32_16x16x32_bf16 v[72:75], v[132:135], v[160:163], v[72:75]
    v_mfma_f32_16x16x32_bf16 v[76:79], v[132:135], v[164:167], v[76:79]
    v_mfma_f32_16x16x32_bf16 v[80:83], v[132:135], v[168:171], v[80:83]
    v_mfma_f32_16x16x32_bf16 v[84:87], v[136:139], v[156:159], v[84:87]
    v_mfma_f32_16x16x32_bf16 v[88:91], v[136:139], v[160:163], v[88:91]
    v_mfma_f32_16x16x32_bf16 v[92:95], v[136:139], v[164:167], v[92:95]
    v_mfma_f32_16x16x32_bf16 v[96:99], v[136:139], v[168:171], v[96:99]
    s_add_u32 s39, s39, 1
    s_cmp_lt_u32 s39, 8
    s_cbranch_scc1 L_gemm2_kernel_tail
    s_nop 7
    v_lshrrev_b32 v13, 6, v0
    v_and_b32 v14, 15, v0
    v_and_b32 v15, 1, v13
    v_lshl_add_u32 v14, v15, 6, v14
    s_lshl_b32 s18, s19, 7
    s_lshl_b32 s20, s16, 11
    s_add_u32 s18, s18, s20
    v_add_u32 v14, s18, v14
    v_mul_u32_u24 v14, 1280, v14
    v_lshrrev_b32 v15, 1, v13
    v_mul_u32_u24 v15, 80, v15
    v_bfe_u32 v16, v0, 4, 2
    v_lshl_add_u32 v15, v16, 2, v15
    s_mul_i32 s18, s17, 160
    v_add_u32 v15, s18, v15
    v_lshl_add_u32 v14, v15, 1, v14
    v_cvt_pk_bf16_f32 v20, v20, v21
    v_cvt_pk_bf16_f32 v21, v22, v23
    s_mov_b32 s18, 0
    buffer_store_dwordx2 v[20:21], v14, s[28:31], s18 offen
    v_cvt_pk_bf16_f32 v24, v24, v25
    v_cvt_pk_bf16_f32 v25, v26, v27
    s_mov_b32 s18, 20480
    buffer_store_dwordx2 v[24:25], v14, s[28:31], s18 offen
    v_cvt_pk_bf16_f32 v28, v28, v29
    v_cvt_pk_bf16_f32 v29, v30, v31
    s_mov_b32 s18, 40960
    buffer_store_dwordx2 v[28:29], v14, s[28:31], s18 offen
    v_cvt_pk_bf16_f32 v32, v32, v33
    v_cvt_pk_bf16_f32 v33, v34, v35
    s_mov_b32 s18, 61440
    buffer_store_dwordx2 v[32:33], v14, s[28:31], s18 offen
    v_cvt_pk_bf16_f32 v36, v36, v37
    v_cvt_pk_bf16_f32 v37, v38, v39
    s_mov_b32 s18, 32
    buffer_store_dwordx2 v[36:37], v14, s[28:31], s18 offen
    v_cvt_pk_bf16_f32 v40, v40, v41
    v_cvt_pk_bf16_f32 v41, v42, v43
    s_mov_b32 s18, 20512
    buffer_store_dwordx2 v[40:41], v14, s[28:31], s18 offen
    v_cvt_pk_bf16_f32 v44, v44, v45
    v_cvt_pk_bf16_f32 v45, v46, v47
    s_mov_b32 s18, 40992
    buffer_store_dwordx2 v[44:45], v14, s[28:31], s18 offen
    v_cvt_pk_bf16_f32 v48, v48, v49
    v_cvt_pk_bf16_f32 v49, v50, v51
    s_mov_b32 s18, 61472
    buffer_store_dwordx2 v[48:49], v14, s[28:31], s18 offen
    v_cvt_pk_bf16_f32 v52, v52, v53
    v_cvt_pk_bf16_f32 v53, v54, v55
    s_mov_b32 s18, 64
    buffer_store_dwordx2 v[52:53], v14, s[28:31], s18 offen
    v_cvt_pk_bf16_f32 v56, v56, v57
    v_cvt_pk_bf16_f32 v57, v58, v59
    s_mov_b32 s18, 20544
    buffer_store_dwordx2 v[56:57], v14, s[28:31], s18 offen
    v_cvt_pk_bf16_f32 v60, v60, v61
    v_cvt_pk_bf16_f32 v61, v62, v63
    s_mov_b32 s18, 41024
    buffer_store_dwordx2 v[60:61], v14, s[28:31], s18 offen
    v_cvt_pk_bf16_f32 v64, v64, v65
    v_cvt_pk_bf16_f32 v65, v66, v67
    s_mov_b32 s18, 61504
    buffer_store_dwordx2 v[64:65], v14, s[28:31], s18 offen
    v_cvt_pk_bf16_f32 v68, v68, v69
    v_cvt_pk_bf16_f32 v69, v70, v71
    s_mov_b32 s18, 96
    buffer_store_dwordx2 v[68:69], v14, s[28:31], s18 offen
    v_cvt_pk_bf16_f32 v72, v72, v73
    v_cvt_pk_bf16_f32 v73, v74, v75
    s_mov_b32 s18, 20576
    buffer_store_dwordx2 v[72:73], v14, s[28:31], s18 offen
    v_cvt_pk_bf16_f32 v76, v76, v77
    v_cvt_pk_bf16_f32 v77, v78, v79
    s_mov_b32 s18, 41056
    buffer_store_dwordx2 v[76:77], v14, s[28:31], s18 offen
    v_cvt_pk_bf16_f32 v80, v80, v81
    v_cvt_pk_bf16_f32 v81, v82, v83
    s_mov_b32 s18, 61536
    buffer_store_dwordx2 v[80:81], v14, s[28:31], s18 offen
    v_cvt_pk_bf16_f32 v84, v84, v85
    v_cvt_pk_bf16_f32 v85, v86, v87
    s_mov_b32 s18, 128
    buffer_store_dwordx2 v[84:85], v14, s[28:31], s18 offen
    v_cvt_pk_bf16_f32 v88, v88, v89
    v_cvt_pk_bf16_f32 v89, v90, v91
    s_mov_b32 s18, 20608
    buffer_store_dwordx2 v[88:89], v14, s[28:31], s18 offen
    v_cvt_pk_bf16_f32 v92, v92, v93
    v_cvt_pk_bf16_f32 v93, v94, v95
    s_mov_b32 s18, 41088
    buffer_store_dwordx2 v[92:93], v14, s[28:31], s18 offen
    v_cvt_pk_bf16_f32 v96, v96, v97
    v_cvt_pk_bf16_f32 v97, v98, v99
    s_mov_b32 s18, 61568
    buffer_store_dwordx2 v[96:97], v14, s[28:31], s18 offen
L_gemm2_kernel_end:
    s_endpgm
.globl ln2_kernel
.p2align 8
.type ln2_kernel,@function
ln2_kernel:
    s_cmp_ge_u32 s2, 512
    s_cbranch_scc1 L_k3_end
    s_load_dwordx2 s[4:5], s[0:1], 0
    s_load_dwordx2 s[6:7], s[0:1], 96
    s_load_dwordx2 s[40:41], s[0:1], 48
    s_load_dwordx2 s[42:43], s[0:1], 80
    v_lshrrev_b32 v1, 6, v0
    v_and_b32 v2, 63, v0
    s_lshl_b32 s3, s2, 2
    v_add_u32 v1, s3, v1
    v_mul_u32_u24 v3, 1280, v1
    v_lshl_add_u32 v3, v2, 2, v3
    v_lshlrev_b32 v4, 1, v3
    v_lshlrev_b32 v5, 2, v2
    s_waitcnt lgkmcnt(0)
    s_mov_b32 s8, s4
    s_mov_b32 s9, s5
    s_mov_b32 s10, 2621440
    s_mov_b32 s11, 0x00020000
    s_add_u32 s12, s6, 16777216
    s_addc_u32 s13, s7, 0
    s_mov_b32 s14, 10485760
    s_mov_b32 s15, 0x00020000
    s_mov_b32 s16, s40
    s_mov_b32 s17, s41
    s_mov_b32 s18, 1280
    s_mov_b32 s19, 0x00020000
    s_mov_b32 s44, s42
    s_mov_b32 s45, s43
    s_mov_b32 s46, 2621440
    s_mov_b32 s47, 0x00020000
    s_add_u32 s48, s6, 41943040
    s_addc_u32 s49, s7, 0
    s_mov_b32 s50, 2621440
    s_mov_b32 s51, 0x00020000
    s_add_u32 s52, s6, 46137344
    s_addc_u32 s53, s7, 0
    s_mov_b32 s54, 2621440
    s_mov_b32 s55, 0x00020000
    s_add_u32 s56, s6, 50331648
    s_addc_u32 s57, s7, 0
    s_mov_b32 s58, 8192
    s_mov_b32 s59, 0x00020000
    buffer_load_dword v10, v3, s[8:11], 0 offen offset:0
    buffer_load_dword v11, v3, s[8:11], 0 offen offset:256
    buffer_load_dword v12, v3, s[8:11], 0 offen offset:512
    buffer_load_dword v13, v3, s[8:11], 0 offen offset:768
    buffer_load_dword v14, v3, s[8:11], 0 offen offset:1024
    s_mov_b32 s3, 0
    buffer_load_dword v21, v3, s[12:15], s3 offen offset:0
    buffer_load_dword v23, v3, s[12:15], s3 offen offset:256
    buffer_load_dword v25, v3, s[12:15], s3 offen offset:512
    buffer_load_dword v27, v3, s[12:15], s3 offen offset:768
    buffer_load_dword v29, v3, s[12:15], s3 offen offset:1024
    s_mov_b32 s3, 2621440
    buffer_load_dword v31, v3, s[12:15], s3 offen offset:0
    buffer_load_dword v33, v3, s[12:15], s3 offen offset:256
    buffer_load_dword v35, v3, s[12:15], s3 offen offset:512
    buffer_load_dword v37, v3, s[12:15], s3 offen offset:768
    buffer_load_dword v39, v3, s[12:15], s3 offen offset:1024
    s_mov_b32 s3, 5242880
    buffer_load_dword v41, v3, s[12:15], s3 offen offset:0
    buffer_load_dword v43, v3, s[12:15], s3 offen offset:256
    buffer_load_dword v45, v3, s[12:15], s3 offen offset:512
    buffer_load_dword v47, v3, s[12:15], s3 offen offset:768
    buffer_load_dword v49, v3, s[12:15], s3 offen offset:1024
    s_mov_b32 s3, 7864320
    buffer_load_dword v51, v3, s[12:15], s3 offen offset:0
    buffer_load_dword v53, v3, s[12:15], s3 offen offset:256
    buffer_load_dword v55, v3, s[12:15], s3 offen offset:512
    buffer_load_dword v57, v3, s[12:15], s3 offen offset:768
    buffer_load_dword v59, v3, s[12:15], s3 offen offset:1024
    buffer_load_dword v60, v5, s[16:19], 0 offen offset:0
    buffer_load_dword v61, v5, s[16:19], 0 offen offset:256
    buffer_load_dword v62, v5, s[16:19], 0 offen offset:512
    buffer_load_dword v63, v5, s[16:19], 0 offen offset:768
    buffer_load_dword v64, v5, s[16:19], 0 offen offset:1024
    s_waitcnt vmcnt(0)
    v_lshlrev_b32 v20, 16, v21
    v_and_b32 v21, 0xffff0000, v21
    v_lshlrev_b32 v22, 16, v23
    v_and_b32 v23, 0xffff0000, v23
    v_lshlrev_b32 v24, 16, v25
    v_and_b32 v25, 0xffff0000, v25
    v_lshlrev_b32 v26, 16, v27
    v_and_b32 v27, 0xffff0000, v27
    v_lshlrev_b32 v28, 16, v29
    v_and_b32 v29, 0xffff0000, v29
    v_lshlrev_b32 v30, 16, v31
    v_and_b32 v31, 0xffff0000, v31
    v_lshlrev_b32 v32, 16, v33
    v_and_b32 v33, 0xffff0000, v33
    v_lshlrev_b32 v34, 16, v35
    v_and_b32 v35, 0xffff0000, v35
    v_lshlrev_b32 v36, 16, v37
    v_and_b32 v37, 0xffff0000, v37
    v_lshlrev_b32 v38, 16, v39
    v_and_b32 v39, 0xffff0000, v39
    v_lshlrev_b32 v40, 16, v41
    v_and_b32 v41, 0xffff0000, v41
    v_lshlrev_b32 v42, 16, v43
    v_and_b32 v43, 0xffff0000, v43
    v_lshlrev_b32 v44, 16, v45
    v_and_b32 v45, 0xffff0000, v45
    v_lshlrev_b32 v46, 16, v47
    v_and_b32 v47, 0xffff0000, v47
    v_lshlrev_b32 v48, 16, v49
    v_and_b32 v49, 0xffff0000, v49
    v_lshlrev_b32 v50, 16, v51
    v_and_b32 v51, 0xffff0000, v51
    v_lshlrev_b32 v52, 16, v53
    v_and_b32 v53, 0xffff0000, v53
    v_lshlrev_b32 v54, 16, v55
    v_and_b32 v55, 0xffff0000, v55
    v_lshlrev_b32 v56, 16, v57
    v_and_b32 v57, 0xffff0000, v57
    v_lshlrev_b32 v58, 16, v59
    v_and_b32 v59, 0xffff0000, v59
    v_add_f32 v6, v20, v30
    v_cvt_pk_bf16_f32 v6, v6, v6
    v_lshlrev_b32 v6, 16, v6
    v_add_f32 v7, v40, v50
    v_cvt_pk_bf16_f32 v7, v7, v7
    v_lshlrev_b32 v7, 16, v7
    v_sub_f32 v6, v6, v7
    v_cvt_pk_bf16_f32 v6, v6, v6
    v_lshlrev_b32 v6, 16, v6
    v_lshlrev_b32 v7, 16, v10
    v_add_f32 v6, v7, v6
    v_cvt_pk_bf16_f32 v70, v6, v6
    v_lshlrev_b32 v70, 16, v70
    v_add_f32 v6, v21, v31
    v_cvt_pk_bf16_f32 v6, v6, v6
    v_lshlrev_b32 v6, 16, v6
    v_add_f32 v7, v41, v51
    v_cvt_pk_bf16_f32 v7, v7, v7
    v_lshlrev_b32 v7, 16, v7
    v_sub_f32 v6, v6, v7
    v_cvt_pk_bf16_f32 v6, v6, v6
    v_lshlrev_b32 v6, 16, v6
    v_and_b32 v7, 0xffff0000, v10
    v_add_f32 v6, v7, v6
    v_cvt_pk_bf16_f32 v71, v6, v6
    v_lshlrev_b32 v71, 16, v71
    v_add_f32 v6, v22, v32
    v_cvt_pk_bf16_f32 v6, v6, v6
    v_lshlrev_b32 v6, 16, v6
    v_add_f32 v7, v42, v52
    v_cvt_pk_bf16_f32 v7, v7, v7
    v_lshlrev_b32 v7, 16, v7
    v_sub_f32 v6, v6, v7
    v_cvt_pk_bf16_f32 v6, v6, v6
    v_lshlrev_b32 v6, 16, v6
    v_lshlrev_b32 v7, 16, v11
    v_add_f32 v6, v7, v6
    v_cvt_pk_bf16_f32 v72, v6, v6
    v_lshlrev_b32 v72, 16, v72
    v_add_f32 v6, v23, v33
    v_cvt_pk_bf16_f32 v6, v6, v6
    v_lshlrev_b32 v6, 16, v6
    v_add_f32 v7, v43, v53
    v_cvt_pk_bf16_f32 v7, v7, v7
    v_lshlrev_b32 v7, 16, v7
    v_sub_f32 v6, v6, v7
    v_cvt_pk_bf16_f32 v6, v6, v6
    v_lshlrev_b32 v6, 16, v6
    v_and_b32 v7, 0xffff0000, v11
    v_add_f32 v6, v7, v6
    v_cvt_pk_bf16_f32 v73, v6, v6
    v_lshlrev_b32 v73, 16, v73
    v_add_f32 v6, v24, v34
    v_cvt_pk_bf16_f32 v6, v6, v6
    v_lshlrev_b32 v6, 16, v6
    v_add_f32 v7, v44, v54
    v_cvt_pk_bf16_f32 v7, v7, v7
    v_lshlrev_b32 v7, 16, v7
    v_sub_f32 v6, v6, v7
    v_cvt_pk_bf16_f32 v6, v6, v6
    v_lshlrev_b32 v6, 16, v6
    v_lshlrev_b32 v7, 16, v12
    v_add_f32 v6, v7, v6
    v_cvt_pk_bf16_f32 v74, v6, v6
    v_lshlrev_b32 v74, 16, v74
    v_add_f32 v6, v25, v35
    v_cvt_pk_bf16_f32 v6, v6, v6
    v_lshlrev_b32 v6, 16, v6
    v_add_f32 v7, v45, v55
    v_cvt_pk_bf16_f32 v7, v7, v7
    v_lshlrev_b32 v7, 16, v7
    v_sub_f32 v6, v6, v7
    v_cvt_pk_bf16_f32 v6, v6, v6
    v_lshlrev_b32 v6, 16, v6
    v_and_b32 v7, 0xffff0000, v12
    v_add_f32 v6, v7, v6
    v_cvt_pk_bf16_f32 v75, v6, v6
    v_lshlrev_b32 v75, 16, v75
    v_add_f32 v6, v26, v36
    v_cvt_pk_bf16_f32 v6, v6, v6
    v_lshlrev_b32 v6, 16, v6
    v_add_f32 v7, v46, v56
    v_cvt_pk_bf16_f32 v7, v7, v7
    v_lshlrev_b32 v7, 16, v7
    v_sub_f32 v6, v6, v7
    v_cvt_pk_bf16_f32 v6, v6, v6
    v_lshlrev_b32 v6, 16, v6
    v_lshlrev_b32 v7, 16, v13
    v_add_f32 v6, v7, v6
    v_cvt_pk_bf16_f32 v76, v6, v6
    v_lshlrev_b32 v76, 16, v76
    v_add_f32 v6, v27, v37
    v_cvt_pk_bf16_f32 v6, v6, v6
    v_lshlrev_b32 v6, 16, v6
    v_add_f32 v7, v47, v57
    v_cvt_pk_bf16_f32 v7, v7, v7
    v_lshlrev_b32 v7, 16, v7
    v_sub_f32 v6, v6, v7
    v_cvt_pk_bf16_f32 v6, v6, v6
    v_lshlrev_b32 v6, 16, v6
    v_and_b32 v7, 0xffff0000, v13
    v_add_f32 v6, v7, v6
    v_cvt_pk_bf16_f32 v77, v6, v6
    v_lshlrev_b32 v77, 16, v77
    v_add_f32 v6, v28, v38
    v_cvt_pk_bf16_f32 v6, v6, v6
    v_lshlrev_b32 v6, 16, v6
    v_add_f32 v7, v48, v58
    v_cvt_pk_bf16_f32 v7, v7, v7
    v_lshlrev_b32 v7, 16, v7
    v_sub_f32 v6, v6, v7
    v_cvt_pk_bf16_f32 v6, v6, v6
    v_lshlrev_b32 v6, 16, v6
    v_lshlrev_b32 v7, 16, v14
    v_add_f32 v6, v7, v6
    v_cvt_pk_bf16_f32 v78, v6, v6
    v_lshlrev_b32 v78, 16, v78
    v_add_f32 v6, v29, v39
    v_cvt_pk_bf16_f32 v6, v6, v6
    v_lshlrev_b32 v6, 16, v6
    v_add_f32 v7, v49, v59
    v_cvt_pk_bf16_f32 v7, v7, v7
    v_lshlrev_b32 v7, 16, v7
    v_sub_f32 v6, v6, v7
    v_cvt_pk_bf16_f32 v6, v6, v6
    v_lshlrev_b32 v6, 16, v6
    v_and_b32 v7, 0xffff0000, v14
    v_add_f32 v6, v7, v6
    v_cvt_pk_bf16_f32 v79, v6, v6
    v_lshlrev_b32 v79, 16, v79
    v_add_f32 v90, v70, v71
    v_add_f32 v90, v90, v72
    v_add_f32 v90, v90, v73
    v_add_f32 v90, v90, v74
    v_add_f32 v90, v90, v75
    v_add_f32 v90, v90, v76
    v_add_f32 v90, v90, v77
    v_add_f32 v90, v90, v78
    v_add_f32 v90, v90, v79
    s_nop 1
    v_add_f32_dpp v90, v90, v90 quad_perm:[1,0,3,2] row_mask:0xf bank_mask:0xf
    s_nop 1
    v_add_f32_dpp v90, v90, v90 quad_perm:[2,3,0,1] row_mask:0xf bank_mask:0xf
    s_nop 1
    v_add_f32_dpp v90, v90, v90 row_half_mirror row_mask:0xf bank_mask:0xf
    s_nop 1
    v_add_f32_dpp v90, v90, v90 row_mirror row_mask:0xf bank_mask:0xf
    s_nop 1
    v_readlane_b32 s20, v90, 0
    v_readlane_b32 s21, v90, 16
    v_readlane_b32 s22, v90, 32
    v_readlane_b32 s23, v90, 48
    s_nop 1
    v_mov_b32 v90, s20
    v_add_f32 v90, s21, v90
    v_add_f32 v90, s22, v90
    v_add_f32 v90, s23, v90
    v_mul_f32 v90, 0.0015625, v90
    v_sub_f32 v91, v70, v90
    v_mul_f32 v92, v91, v91
    v_sub_f32 v91, v71, v90
    v_fmac_f32 v92, v91, v91
    v_sub_f32 v91, v72, v90
    v_fmac_f32 v92, v91, v91
    v_sub_f32 v91, v73, v90
    v_fmac_f32 v92, v91, v91
    v_sub_f32 v91, v74, v90
    v_fmac_f32 v92, v91, v91
    v_sub_f32 v91, v75, v90
    v_fmac_f32 v92, v91, v91
    v_sub_f32 v91, v76, v90
    v_fmac_f32 v92, v91, v91
    v_sub_f32 v91, v77, v90
    v_fmac_f32 v92, v91, v91
    v_sub_f32 v91, v78, v90
    v_fmac_f32 v92, v91, v91
    v_sub_f32 v91, v79, v90
    v_fmac_f32 v92, v91, v91
    s_nop 1
    v_add_f32_dpp v92, v92, v92 quad_perm:[1,0,3,2] row_mask:0xf bank_mask:0xf
    s_nop 1
    v_add_f32_dpp v92, v92, v92 quad_perm:[2,3,0,1] row_mask:0xf bank_mask:0xf
    s_nop 1
    v_add_f32_dpp v92, v92, v92 row_half_mirror row_mask:0xf bank_mask:0xf
    s_nop 1
    v_add_f32_dpp v92, v92, v92 row_mirror row_mask:0xf bank_mask:0xf
    s_nop 1
    v_readlane_b32 s20, v92, 0
    v_readlane_b32 s21, v92, 16
    v_readlane_b32 s22, v92, 32
    v_readlane_b32 s23, v92, 48
    s_nop 1
    v_mov_b32 v92, s20
    v_add_f32 v92, s21, v92
    v_add_f32 v92, s22, v92
    v_add_f32 v92, s23, v92
    v_mul_f32 v92, 0.0015625, v92
    v_cvt_pk_bf16_f32 v92, v92, v92
    v_lshlrev_b32 v92, 16, v92
    v_add_f32 v92, 0x3727c5ac, v92
    v_cvt_pk_bf16_f32 v92, v92, v92
    v_lshlrev_b32 v92, 16, v92
    v_sqrt_f32 v92, v92
    s_nop 0
    v_cvt_pk_bf16_f32 v92, v92, v92
    v_lshlrev_b32 v92, 16, v92
    v_rcp_f32 v92, v92
    v_cvt_pk_bf16_f32 v90, v90, v90
    v_lshlrev_b32 v90, 16, v90
    v_sub_f32 v91, v70, v90
    v_cvt_pk_bf16_f32 v91, v91, v91
    v_lshlrev_b32 v91, 16, v91
    v_mul_f32 v91, v91, v92
    v_cvt_pk_bf16_f32 v80, v91, v91
    v_lshlrev_b32 v80, 16, v80
    v_sub_f32 v91, v71, v90
    v_cvt_pk_bf16_f32 v91, v91, v91
    v_lshlrev_b32 v91, 16, v91
    v_mul_f32 v91, v91, v92
    v_cvt_pk_bf16_f32 v81, v91, v91
    v_lshlrev_b32 v81, 16, v81
    v_sub_f32 v91, v72, v90
    v_cvt_pk_bf16_f32 v91, v91, v91
    v_lshlrev_b32 v91, 16, v91
    v_mul_f32 v91, v91, v92
    v_cvt_pk_bf16_f32 v82, v91, v91
    v_lshlrev_b32 v82, 16, v82
    v_sub_f32 v91, v73, v90
    v_cvt_pk_bf16_f32 v91, v91, v91
    v_lshlrev_b32 v91, 16, v91
    v_mul_f32 v91, v91, v92
    v_cvt_pk_bf16_f32 v83, v91, v91
    v_lshlrev_b32 v83, 16, v83
    v_sub_f32 v91, v74, v90
    v_cvt_pk_bf16_f32 v91, v91, v91
    v_lshlrev_b32 v91, 16, v91
    v_mul_f32 v91, v91, v92
    v_cvt_pk_bf16_f32 v84, v91, v91
    v_lshlrev_b32 v84, 16, v84
    v_sub_f32 v91, v75, v90
    v_cvt_pk_bf16_f32 v91, v91, v91
    v_lshlrev_b32 v91, 16, v91
    v_mul_f32 v91, v91, v92
    v_cvt_pk_bf16_f32 v85, v91, v91
    v_lshlrev_b32 v85, 16, v85
    v_sub_f32 v91, v76, v90
    v_cvt_pk_bf16_f32 v91, v91, v91
    v_lshlrev_b32 v91, 16, v91
    v_mul_f32 v91, v91, v92
    v_cvt_pk_bf16_f32 v86, v91, v91
    v_lshlrev_b32 v86, 16, v86
    v_sub_f32 v91, v77, v90
    v_cvt_pk_bf16_f32 v91, v91, v91
    v_lshlrev_b32 v91, 16, v91
    v_mul_f32 v91, v91, v92
    v_cvt_pk_bf16_f32 v87, v91, v91
    v_lshlrev_b32 v87, 16, v87
    v_sub_f32 v91, v78, v90
    v_cvt_pk_bf16_f32 v91, v91, v91
    v_lshlrev_b32 v91, 16, v91
    v_mul_f32 v91, v91, v92
    v_cvt_pk_bf16_f32 v88, v91, v91
    v_lshlrev_b32 v88, 16, v88
    v_sub_f32 v91, v79, v90
    v_cvt_pk_bf16_f32 v91, v91, v91
    v_lshlrev_b32 v91, 16, v91
    v_mul_f32 v91, v91, v92
    v_cvt_pk_bf16_f32 v89, v91, v91
    v_lshlrev_b32 v89, 16, v89
    v_lshlrev_b32 v6, 16, v60
    v_and_b32 v7, 0xffff0000, v60
    v_mul_f32 v8, v6, v80
    v_fmac_f32 v8, v7, v81
    v_lshlrev_b32 v6, 16, v61
    v_and_b32 v7, 0xffff0000, v61
    v_fmac_f32 v8, v6, v82
    v_fmac_f32 v8, v7, v83
    v_lshlrev_b32 v6, 16, v62
    v_and_b32 v7, 0xffff0000, v62
    v_fmac_f32 v8, v6, v84
    v_fmac_f32 v8, v7, v85
    v_lshlrev_b32 v6, 16, v63
    v_and_b32 v7, 0xffff0000, v63
    v_fmac_f32 v8, v6, v86
    v_fmac_f32 v8, v7, v87
    v_lshlrev_b32 v6, 16, v64
    v_and_b32 v7, 0xffff0000, v64
    v_fmac_f32 v8, v6, v88
    v_fmac_f32 v8, v7, v89
    s_nop 1
    v_add_f32_dpp v8, v8, v8 quad_perm:[1,0,3,2] row_mask:0xf bank_mask:0xf
    s_nop 1
    v_add_f32_dpp v8, v8, v8 quad_perm:[2,3,0,1] row_mask:0xf bank_mask:0xf
    s_nop 1
    v_add_f32_dpp v8, v8, v8 row_half_mirror row_mask:0xf bank_mask:0xf
    s_nop 1
    v_add_f32_dpp v8, v8, v8 row_mirror row_mask:0xf bank_mask:0xf
    s_nop 1
    v_readlane_b32 s20, v8, 0
    v_readlane_b32 s21, v8, 16
    v_readlane_b32 s22, v8, 32
    v_readlane_b32 s23, v8, 48
    s_nop 1
    v_mov_b32 v8, s20
    v_add_f32 v8, s21, v8
    v_add_f32 v8, s22, v8
    v_add_f32 v8, s23, v8
    v_cvt_pk_bf16_f32 v8, v8, v8
    v_lshlrev_b32 v8, 16, v8
    v_lshlrev_b32 v9, 2, v1
    v_cmp_eq_u32 vcc, 0, v2
    s_and_saveexec_b64 s[60:61], vcc
    buffer_store_dword v8, v9, s[56:59], 0 offen
    s_mov_b64 exec, s[60:61]
    v_cvt_pk_bf16_f32 v6, v70, v71
    buffer_store_dword v6, v3, s[48:51], 0 offen offset:0
    v_cvt_pk_bf16_f32 v7, v80, v81
    buffer_store_dword v7, v3, s[52:55], 0 offen offset:0
    v_add_f32 v8, v70, v80
    v_add_f32 v9, v71, v81
    v_cvt_pk_bf16_f32 v8, v8, v9
    buffer_store_dword v8, v3, s[44:47], 0 offen offset:0
    v_cvt_pk_bf16_f32 v6, v72, v73
    buffer_store_dword v6, v3, s[48:51], 0 offen offset:256
    v_cvt_pk_bf16_f32 v7, v82, v83
    buffer_store_dword v7, v3, s[52:55], 0 offen offset:256
    v_add_f32 v8, v72, v82
    v_add_f32 v9, v73, v83
    v_cvt_pk_bf16_f32 v8, v8, v9
    buffer_store_dword v8, v3, s[44:47], 0 offen offset:256
    v_cvt_pk_bf16_f32 v6, v74, v75
    buffer_store_dword v6, v3, s[48:51], 0 offen offset:512
    v_cvt_pk_bf16_f32 v7, v84, v85
    buffer_store_dword v7, v3, s[52:55], 0 offen offset:512
    v_add_f32 v8, v74, v84
    v_add_f32 v9, v75, v85
    v_cvt_pk_bf16_f32 v8, v8, v9
    buffer_store_dword v8, v3, s[44:47], 0 offen offset:512
    v_cvt_pk_bf16_f32 v6, v76, v77
    buffer_store_dword v6, v3, s[48:51], 0 offen offset:768
    v_cvt_pk_bf16_f32 v7, v86, v87
    buffer_store_dword v7, v3, s[52:55], 0 offen offset:768
    v_add_f32 v8, v76, v86
    v_add_f32 v9, v77, v87
    v_cvt_pk_bf16_f32 v8, v8, v9
    buffer_store_dword v8, v3, s[44:47], 0 offen offset:768
    v_cvt_pk_bf16_f32 v6, v78, v79
    buffer_store_dword v6, v3, s[48:51], 0 offen offset:1024
    v_cvt_pk_bf16_f32 v7, v88, v89
    buffer_store_dword v7, v3, s[52:55], 0 offen offset:1024
    v_add_f32 v8, v78, v88
    v_add_f32 v9, v79, v89
    v_cvt_pk_bf16_f32 v8, v8, v9
    buffer_store_dword v8, v3, s[44:47], 0 offen offset:1024
L_k3_end:
    s_endpgm
.globl ffn1_kernel
.p2align 8
.type ffn1_kernel,@function
ffn1_kernel:
    s_cmp_ge_u32 s2, 96
    s_cbranch_scc1 L_k4_end
    s_load_dwordx2 s[6:7], s[0:1], 96
    s_load_dwordx4 s[40:43], s[0:1], 56
    s_load_dwordx2 s[44:45], s[0:1], 72
    v_lshrrev_b32 v1, 6, v0
    v_and_b32 v22, 15, v0
    v_bfe_u32 v23, v0, 4, 2
    v_readfirstlane_b32 s47, v1
    s_waitcnt lgkmcnt(0)
    s_add_u32 s8, s6, 50331648
    s_addc_u32 s9, s7, 0
    s_mov_b32 s10, 8192
    s_mov_b32 s11, 0x00020000
    s_add_u32 s12, s6, 46137344
    s_addc_u32 s13, s7, 0
    s_mov_b32 s14, 2621440
    s_mov_b32 s15, 0x00020000
    s_mov_b32 s16, s40
    s_mov_b32 s17, s41
    s_mov_b32 s18, 1966080
    s_mov_b32 s19, 0x00020000
    s_mov_b32 s20, s42
    s_mov_b32 s21, s43
    s_mov_b32 s22, 1966080
    s_mov_b32 s23, 0x00020000
    s_add_u32 s24, s6, 54525952
    s_addc_u32 s25, s7, 0
    s_mov_b32 s26, 1966080
    s_mov_b32 s27, 0x00020000
    s_add_u32 s28, s6, 50462720
    s_addc_u32 s29, s7, 0
    s_mov_b32 s30, 32
    s_mov_b32 s31, 0x00020000
    s_mov_b32 s48, s44
    s_mov_b32 s49, s45
    s_mov_b32 s50, 1966080
    s_mov_b32 s51, 0x00020000
    v_mul_u32_u24 v24, 24576, v23
    v_lshl_add_u32 v24, v22, 1, v24
    s_mul_i32 s52, s47, 491520
    s_lshl_b32 s3, s2, 5
    s_add_u32 s52, s52, s3
    s_add_u32 s3, s52, 0
    buffer_load_ushort v128, v24, s[16:19], s3 offen
    buffer_load_ushort v168, v24, s[20:23], s3 offen
    s_add_u32 s3, s52, 3072
    buffer_load_ushort v129, v24, s[16:19], s3 offen
    buffer_load_ushort v169, v24, s[20:23], s3 offen
    s_add_u32 s3, s52, 6144
    buffer_load_ushort v130, v24, s[16:19], s3 offen
    buffer_load_ushort v170, v24, s[20:23], s3 offen
    s_add_u32 s3, s52, 9216
    buffer_load_ushort v131, v24, s[16:19], s3 offen
    buffer_load_ushort v171, v24, s[20:23], s3 offen
    s_add_u32 s3, s52, 12288
    buffer_load_ushort v132, v24, s[16:19], s3 offen
    buffer_load_ushort v172, v24, s[20:23], s3 offen
    s_add_u32 s3, s52, 15360
    buffer_load_ushort v133, v24, s[16:19], s3 offen
    buffer_load_ushort v173, v24, s[20:23], s3 offen
    s_add_u32 s3, s52, 18432
    buffer_load_ushort v134, v24, s[16:19], s3 offen
    buffer_load_ushort v174, v24, s[20:23], s3 offen
    s_add_u32 s3, s52, 21504
    buffer_load_ushort v135, v24, s[16:19], s3 offen
    buffer_load_ushort v175, v24, s[20:23], s3 offen
    s_add_u32 s3, s52, 98304
    buffer_load_ushort v136, v24, s[16:19], s3 offen
    buffer_load_ushort v176, v24, s[20:23], s3 offen
    s_add_u32 s3, s52, 101376
    buffer_load_ushort v137, v24, s[16:19], s3 offen
    buffer_load_ushort v177, v24, s[20:23], s3 offen
    s_add_u32 s3, s52, 104448
    buffer_load_ushort v138, v24, s[16:19], s3 offen
    buffer_load_ushort v178, v24, s[20:23], s3 offen
    s_add_u32 s3, s52, 107520
    buffer_load_ushort v139, v24, s[16:19], s3 offen
    buffer_load_ushort v179, v24, s[20:23], s3 offen
    s_add_u32 s3, s52, 110592
    buffer_load_ushort v140, v24, s[16:19], s3 offen
    buffer_load_ushort v180, v24, s[20:23], s3 offen
    s_add_u32 s3, s52, 113664
    buffer_load_ushort v141, v24, s[16:19], s3 offen
    buffer_load_ushort v181, v24, s[20:23], s3 offen
    s_add_u32 s3, s52, 116736
    buffer_load_ushort v142, v24, s[16:19], s3 offen
    buffer_load_ushort v182, v24, s[20:23], s3 offen
    s_add_u32 s3, s52, 119808
    buffer_load_ushort v143, v24, s[16:19], s3 offen
    buffer_load_ushort v183, v24, s[20:23], s3 offen
    s_add_u32 s3, s52, 196608
    buffer_load_ushort v144, v24, s[16:19], s3 offen
    buffer_load_ushort v184, v24, s[20:23], s3 offen
    s_add_u32 s3, s52, 199680
    buffer_load_ushort v145, v24, s[16:19], s3 offen
    buffer_load_ushort v185, v24, s[20:23], s3 offen
    s_add_u32 s3, s52, 202752
    buffer_load_ushort v146, v24, s[16:19], s3 offen
    buffer_load_ushort v186, v24, s[20:23], s3 offen
    s_add_u32 s3, s52, 205824
    buffer_load_ushort v147, v24, s[16:19], s3 offen
    buffer_load_ushort v187, v24, s[20:23], s3 offen
    s_add_u32 s3, s52, 208896
    buffer_load_ushort v148, v24, s[16:19], s3 offen
    buffer_load_ushort v188, v24, s[20:23], s3 offen
    s_add_u32 s3, s52, 211968
    buffer_load_ushort v149, v24, s[16:19], s3 offen
    buffer_load_ushort v189, v24, s[20:23], s3 offen
    s_add_u32 s3, s52, 215040
    buffer_load_ushort v150, v24, s[16:19], s3 offen
    buffer_load_ushort v190, v24, s[20:23], s3 offen
    s_add_u32 s3, s52, 218112
    buffer_load_ushort v151, v24, s[16:19], s3 offen
    buffer_load_ushort v191, v24, s[20:23], s3 offen
    s_add_u32 s3, s52, 294912
    buffer_load_ushort v152, v24, s[16:19], s3 offen
    buffer_load_ushort v192, v24, s[20:23], s3 offen
    s_add_u32 s3, s52, 297984
    buffer_load_ushort v153, v24, s[16:19], s3 offen
    buffer_load_ushort v193, v24, s[20:23], s3 offen
    s_add_u32 s3, s52, 301056
    buffer_load_ushort v154, v24, s[16:19], s3 offen
    buffer_load_ushort v194, v24, s[20:23], s3 offen
    s_add_u32 s3, s52, 304128
    buffer_load_ushort v155, v24, s[16:19], s3 offen
    buffer_load_ushort v195, v24, s[20:23], s3 offen
    s_add_u32 s3, s52, 307200
    buffer_load_ushort v156, v24, s[16:19], s3 offen
    buffer_load_ushort v196, v24, s[20:23], s3 offen
    s_add_u32 s3, s52, 310272
    buffer_load_ushort v157, v24, s[16:19], s3 offen
    buffer_load_ushort v197, v24, s[20:23], s3 offen
    s_add_u32 s3, s52, 313344
    buffer_load_ushort v158, v24, s[16:19], s3 offen
    buffer_load_ushort v198, v24, s[20:23], s3 offen
    s_add_u32 s3, s52, 316416
    buffer_load_ushort v159, v24, s[16:19], s3 offen
    buffer_load_ushort v199, v24, s[20:23], s3 offen
    s_add_u32 s3, s52, 393216
    buffer_load_ushort v160, v24, s[16:19], s3 offen
    buffer_load_ushort v200, v24, s[20:23], s3 offen
    s_add_u32 s3, s52, 396288
    buffer_load_ushort v161, v24, s[16:19], s3 offen
    buffer_load_ushort v201, v24, s[20:23], s3 offen
    s_add_u32 s3, s52, 399360
    buffer_load_ushort v162, v24, s[16:19], s3 offen
    buffer_load_ushort v202, v24, s[20:23], s3 offen
    s_add_u32 s3, s52, 402432
    buffer_load_ushort v163, v24, s[16:19], s3 offen
    buffer_load_ushort v203, v24, s[20:23], s3 offen
    s_add_u32 s3, s52, 405504
    buffer_load_ushort v164, v24, s[16:19], s3 offen
    buffer_load_ushort v204, v24, s[20:23], s3 offen
    s_add_u32 s3, s52, 408576
    buffer_load_ushort v165, v24, s[16:19], s3 offen
    buffer_load_ushort v205, v24, s[20:23], s3 offen
    s_add_u32 s3, s52, 411648
    buffer_load_ushort v166, v24, s[16:19], s3 offen
    buffer_load_ushort v206, v24, s[20:23], s3 offen
    s_add_u32 s3, s52, 414720
    buffer_load_ushort v167, v24, s[16:19], s3 offen
    buffer_load_ushort v207, v24, s[20:23], s3 offen
    v_mul_u32_u24 v25, 5120, v23
    v_lshl_add_u32 v25, v22, 1, v25
    s_mul_i32 s53, s2, 20480
    s_mul_i32 s3, s47, 320
    s_add_u32 s53, s53, s3
    s_add_u32 s3, s53, 0
    buffer_load_ushort v208, v25, s[48:51], s3 offen
    s_add_u32 s3, s53, 1280
    buffer_load_ushort v209, v25, s[48:51], s3 offen
    s_add_u32 s3, s53, 2560
    buffer_load_ushort v210, v25, s[48:51], s3 offen
    s_add_u32 s3, s53, 3840
    buffer_load_ushort v211, v25, s[48:51], s3 offen
    s_add_u32 s3, s53, 32
    buffer_load_ushort v212, v25, s[48:51], s3 offen
    s_add_u32 s3, s53, 1312
    buffer_load_ushort v213, v25, s[48:51], s3 offen
    s_add_u32 s3, s53, 2592
    buffer_load_ushort v214, v25, s[48:51], s3 offen
    s_add_u32 s3, s53, 3872
    buffer_load_ushort v215, v25, s[48:51], s3 offen
    s_add_u32 s3, s53, 64
    buffer_load_ushort v216, v25, s[48:51], s3 offen
    s_add_u32 s3, s53, 1344
    buffer_load_ushort v217, v25, s[48:51], s3 offen
    s_add_u32 s3, s53, 2624
    buffer_load_ushort v218, v25, s[48:51], s3 offen
    s_add_u32 s3, s53, 3904
    buffer_load_ushort v219, v25, s[48:51], s3 offen
    s_add_u32 s3, s53, 96
    buffer_load_ushort v220, v25, s[48:51], s3 offen
    s_add_u32 s3, s53, 1376
    buffer_load_ushort v221, v25, s[48:51], s3 offen
    s_add_u32 s3, s53, 2656
    buffer_load_ushort v222, v25, s[48:51], s3 offen
    s_add_u32 s3, s53, 3936
    buffer_load_ushort v223, v25, s[48:51], s3 offen
    s_add_u32 s3, s53, 128
    buffer_load_ushort v224, v25, s[48:51], s3 offen
    s_add_u32 s3, s53, 1408
    buffer_load_ushort v225, v25, s[48:51], s3 offen
    s_add_u32 s3, s53, 2688
    buffer_load_ushort v226, v25, s[48:51], s3 offen
    s_add_u32 s3, s53, 3968
    buffer_load_ushort v227, v25, s[48:51], s3 offen
    s_add_u32 s3, s53, 160
    buffer_load_ushort v228, v25, s[48:51], s3 offen
    s_add_u32 s3, s53, 1440
    buffer_load_ushort v229, v25, s[48:51], s3 offen
    s_add_u32 s3, s53, 2720
    buffer_load_ushort v230, v25, s[48:51], s3 offen
    s_add_u32 s3, s53, 4000
    buffer_load_ushort v231, v25, s[48:51], s3 offen
    s_add_u32 s3, s53, 192
    buffer_load_ushort v232, v25, s[48:51], s3 offen
    s_add_u32 s3, s53, 1472
    buffer_load_ushort v233, v25, s[48:51], s3 offen
    s_add_u32 s3, s53, 2752
    buffer_load_ushort v234, v25, s[48:51], s3 offen
    s_add_u32 s3, s53, 4032
    buffer_load_ushort v235, v25, s[48:51], s3 offen
    s_add_u32 s3, s53, 224
    buffer_load_ushort v236, v25, s[48:51], s3 offen
    s_add_u32 s3, s53, 1504
    buffer_load_ushort v237, v25, s[48:51], s3 offen
    s_add_u32 s3, s53, 2784
    buffer_load_ushort v238, v25, s[48:51], s3 offen
    s_add_u32 s3, s53, 4064
    buffer_load_ushort v239, v25, s[48:51], s3 offen
    s_add_u32 s3, s53, 256
    buffer_load_ushort v240, v25, s[48:51], s3 offen
    s_add_u32 s3, s53, 1536
    buffer_load_ushort v241, v25, s[48:51], s3 offen
    s_add_u32 s3, s53, 2816
    buffer_load_ushort v242, v25, s[48:51], s3 offen
    s_add_u32 s3, s53, 4096
    buffer_load_ushort v243, v25, s[48:51], s3 offen
    s_add_u32 s3, s53, 288
    buffer_load_ushort v244, v25, s[48:51], s3 offen
    s_add_u32 s3, s53, 1568
    buffer_load_ushort v245, v25, s[48:51], s3 offen
    s_add_u32 s3, s53, 2848
    buffer_load_ushort v246, v25, s[48:51], s3 offen
    s_add_u32 s3, s53, 4128
    buffer_load_ushort v247, v25, s[48:51], s3 offen
    v_lshlrev_b32 v1, 5, v0
    buffer_load_dwordx4 v[4:7], v1, s[8:11], 0 offen
    buffer_load_dwordx4 v[8:11], v1, s[8:11], 0 offen offset:16
    v_lshlrev_b32 v2, 3, v0
    v_sub_u32 v2, 2047, v2
    v_lshrrev_b32 v3, 6, v0
    v_lshlrev_b32 v3, 2, v3
    v_add_u32 v3, 0, v3
    v_mov_b32 v13, 0
    s_waitcnt vmcnt(0)
    v_ashrrev_i32 v12, 31, v4
    v_or_b32 v12, 0x80000000, v12
    v_xor_b32 v4, v4, v12
    v_and_b32 v4, 0xffff0000, v4
    v_subrev_u32 v12, 0, v2
    v_or_b32 v4, v4, v12
    v_ashrrev_i32 v12, 31, v5
    v_or_b32 v12, 0x80000000, v12
    v_xor_b32 v5, v5, v12
    v_and_b32 v5, 0xffff0000, v5
    v_subrev_u32 v12, 1, v2
    v_or_b32 v5, v5, v12
    v_ashrrev_i32 v12, 31, v6
    v_or_b32 v12, 0x80000000, v12
    v_xor_b32 v6, v6, v12
    v_and_b32 v6, 0xffff0000, v6
    v_subrev_u32 v12, 2, v2
    v_or_b32 v6, v6, v12
    v_ashrrev_i32 v12, 31, v7
    v_or_b32 v12, 0x80000000, v12
    v_xor_b32 v7, v7, v12
    v_and_b32 v7, 0xffff0000, v7
    v_subrev_u32 v12, 3, v2
    v_or_b32 v7, v7, v12
    v_ashrrev_i32 v12, 31, v8
    v_or_b32 v12, 0x80000000, v12
    v_xor_b32 v8, v8, v12
    v_and_b32 v8, 0xffff0000, v8
    v_subrev_u32 v12, 4, v2
    v_or_b32 v8, v8, v12
    v_ashrrev_i32 v12, 31, v9
    v_or_b32 v12, 0x80000000, v12
    v_xor_b32 v9, v9, v12
    v_and_b32 v9, 0xffff0000, v9
    v_subrev_u32 v12, 5, v2
    v_or_b32 v9, v9, v12
    v_ashrrev_i32 v12, 31, v10
    v_or_b32 v12, 0x80000000, v12
    v_xor_b32 v10, v10, v12
    v_and_b32 v10, 0xffff0000, v10
    v_subrev_u32 v12, 6, v2
    v_or_b32 v10, v10, v12
    v_ashrrev_i32 v12, 31, v11
    v_or_b32 v12, 0x80000000, v12
    v_xor_b32 v11, v11, v12
    v_and_b32 v11, 0xffff0000, v11
    v_subrev_u32 v12, 7, v2
    v_or_b32 v11, v11, v12
    v_max3_u32 v12, v4, v5, v6
    v_max3_u32 v12, v12, v7, v8
    v_max3_u32 v12, v12, v9, v10
    v_max_u32 v12, v12, v11
    s_nop 1
    v_max_u32_dpp v12, v12, v12 quad_perm:[1,0,3,2] row_mask:0xf bank_mask:0xf
    s_nop 1
    v_max_u32_dpp v12, v12, v12 quad_perm:[2,3,0,1] row_mask:0xf bank_mask:0xf
    s_nop 1
    v_max_u32_dpp v12, v12, v12 row_half_mirror row_mask:0xf bank_mask:0xf
    s_nop 1
    v_max_u32_dpp v12, v12, v12 row_mirror row_mask:0xf bank_mask:0xf
    s_nop 1
    v_readlane_b32 s60, v12, 0
    v_readlane_b32 s61, v12, 16
    v_readlane_b32 s62, v12, 32
    v_readlane_b32 s63, v12, 48
    s_max_u32 s60, s60, s61
    s_max_u32 s62, s62, s63
    s_max_u32 s60, s60, s62
    v_mov_b32 v12, s60
    ds_write_b32 v3, v12 offset:0
    s_waitcnt lgkmcnt(0)
    s_barrier
    ds_read_b128 v[16:19], v13 offset:0
    s_waitcnt lgkmcnt(0)
    v_max3_u32 v12, v16, v17, v18
    v_max_u32 v12, v12, v19
    s_nop 0
    v_readfirstlane_b32 s60, v12
    s_and_b32 s61, s60, 0x7ff
    s_sub_u32 s32, 2047, s61
    v_cmp_ne_u32 vcc, s60, v4
    s_nop 1
    v_cndmask_b32 v4, 0, v4, vcc
    v_cmp_ne_u32 vcc, s60, v5
    s_nop 1
    v_cndmask_b32 v5, 0, v5, vcc
    v_cmp_ne_u32 vcc, s60, v6
    s_nop 1
    v_cndmask_b32 v6, 0, v6, vcc
    v_cmp_ne_u32 vcc, s60, v7
    s_nop 1
    v_cndmask_b32 v7, 0, v7, vcc
    v_cmp_ne_u32 vcc, s60, v8
    s_nop 1
    v_cndmask_b32 v8, 0, v8, vcc
    v_cmp_ne_u32 vcc, s60, v9
    s_nop 1
    v_cndmask_b32 v9, 0, v9, vcc
    v_cmp_ne_u32 vcc, s60, v10
    s_nop 1
    v_cndmask_b32 v10, 0, v10, vcc
    v_cmp_ne_u32 vcc, s60, v11
    s_nop 1
    v_cndmask_b32 v11, 0, v11, vcc
    v_max3_u32 v12, v4, v5, v6
    v_max3_u32 v12, v12, v7, v8
    v_max3_u32 v12, v12, v9, v10
    v_max_u32 v12, v12, v11
    s_nop 1
    v_max_u32_dpp v12, v12, v12 quad_perm:[1,0,3,2] row_mask:0xf bank_mask:0xf
    s_nop 1
    v_max_u32_dpp v12, v12, v12 quad_perm:[2,3,0,1] row_mask:0xf bank_mask:0xf
    s_nop 1
    v_max_u32_dpp v12, v12, v12 row_half_mirror row_mask:0xf bank_mask:0xf
    s_nop 1
    v_max_u32_dpp v12, v12, v12 row_mirror row_mask:0xf bank_mask:0xf
    s_nop 1
    v_readlane_b32 s60, v12, 0
    v_readlane_b32 s61, v12, 16
    v_readlane_b32 s62, v12, 32
    v_readlane_b32 s63, v12, 48
    s_max_u32 s60, s60, s61
    s_max_u32 s62, s62, s63
    s_max_u32 s60, s60, s62
    v_mov_b32 v12, s60
    ds_write_b32 v3, v12 offset:16
    s_waitcnt lgkmcnt(0)
    s_barrier
    ds_read_b128 v[16:19], v13 offset:16
    s_waitcnt lgkmcnt(0)
    v_max3_u32 v12, v16, v17, v18
    v_max_u32 v12, v12, v19
    s_nop 0
    v_readfirstlane_b32 s60, v12
    s_and_b32 s61, s60, 0x7ff
    s_sub_u32 s33, 2047, s61
    v_cmp_ne_u32 vcc, s60, v4
    s_nop 1
    v_cndmask_b32 v4, 0, v4, vcc
    v_cmp_ne_u32 vcc, s60, v5
    s_nop 1
    v_cndmask_b32 v5, 0, v5, vcc
    v_cmp_ne_u32 vcc, s60, v6
    s_nop 1
    v_cndmask_b32 v6, 0, v6, vcc
    v_cmp_ne_u32 vcc, s60, v7
    s_nop 1
    v_cndmask_b32 v7, 0, v7, vcc
    v_cmp_ne_u32 vcc, s60, v8
    s_nop 1
    v_cndmask_b32 v8, 0, v8, vcc
    v_cmp_ne_u32 vcc, s60, v9
    s_nop 1
    v_cndmask_b32 v9, 0, v9, vcc
    v_cmp_ne_u32 vcc, s60, v10
    s_nop 1
    v_cndmask_b32 v10, 0, v10, vcc
    v_cmp_ne_u32 vcc, s60, v11
    s_nop 1
    v_cndmask_b32 v11, 0, v11, vcc
    v_max3_u32 v12, v4, v5, v6
    v_max3_u32 v12, v12, v7, v8
    v_max3_u32 v12, v12, v9, v10
    v_max_u32 v12, v12, v11
    s_nop 1
    v_max_u32_dpp v12, v12, v12 quad_perm:[1,0,3,2] row_mask:0xf bank_mask:0xf
    s_nop 1
    v_max_u32_dpp v12, v12, v12 quad_perm:[2,3,0,1] row_mask:0xf bank_mask:0xf
    s_nop 1
    v_max_u32_dpp v12, v12, v12 row_half_mirror row_mask:0xf bank_mask:0xf
    s_nop 1
    v_max_u32_dpp v12, v12, v12 row_mirror row_mask:0xf bank_mask:0xf
    s_nop 1
    v_readlane_b32 s60, v12, 0
    v_readlane_b32 s61, v12, 16
    v_readlane_b32 s62, v12, 32
    v_readlane_b32 s63, v12, 48
    s_max_u32 s60, s60, s61
    s_max_u32 s62, s62, s63
    s_max_u32 s60, s60, s62
    v_mov_b32 v12, s60
    ds_write_b32 v3, v12 offset:0
    s_waitcnt lgkmcnt(0)
    s_barrier
    ds_read_b128 v[16:19], v13 offset:0
    s_waitcnt lgkmcnt(0)
    v_max3_u32 v12, v16, v17, v18
    v_max_u32 v12, v12, v19
    s_nop 0
    v_readfirstlane_b32 s60, v12
    s_and_b32 s61, s60, 0x7ff
    s_sub_u32 s34, 2047, s61
    v_cmp_ne_u32 vcc, s60, v4
    s_nop 1
    v_cndmask_b32 v4, 0, v4, vcc
    v_cmp_ne_u32 vcc, s60, v5
    s_nop 1
    v_cndmask_b32 v5, 0, v5, vcc
    v_cmp_ne_u32 vcc, s60, v6
    s_nop 1
    v_cndmask_b32 v6, 0, v6, vcc
    v_cmp_ne_u32 vcc, s60, v7
    s_nop 1
    v_cndmask_b32 v7, 0, v7, vcc
    v_cmp_ne_u32 vcc, s60, v8
    s_nop 1
    v_cndmask_b32 v8, 0, v8, vcc
    v_cmp_ne_u32 vcc, s60, v9
    s_nop 1
    v_cndmask_b32 v9, 0, v9, vcc
    v_cmp_ne_u32 vcc, s60, v10
    s_nop 1
    v_cndmask_b32 v10, 0, v10, vcc
    v_cmp_ne_u32 vcc, s60, v11
    s_nop 1
    v_cndmask_b32 v11, 0, v11, vcc
    v_max3_u32 v12, v4, v5, v6
    v_max3_u32 v12, v12, v7, v8
    v_max3_u32 v12, v12, v9, v10
    v_max_u32 v12, v12, v11
    s_nop 1
    v_max_u32_dpp v12, v12, v12 quad_perm:[1,0,3,2] row_mask:0xf bank_mask:0xf
    s_nop 1
    v_max_u32_dpp v12, v12, v12 quad_perm:[2,3,0,1] row_mask:0xf bank_mask:0xf
    s_nop 1
    v_max_u32_dpp v12, v12, v12 row_half_mirror row_mask:0xf bank_mask:0xf
    s_nop 1
    v_max_u32_dpp v12, v12, v12 row_mirror row_mask:0xf bank_mask:0xf
    s_nop 1
    v_readlane_b32 s60, v12, 0
    v_readlane_b32 s61, v12, 16
    v_readlane_b32 s62, v12, 32
    v_readlane_b32 s63, v12, 48
    s_max_u32 s60, s60, s61
    s_max_u32 s62, s62, s63
    s_max_u32 s60, s60, s62
    v_mov_b32 v12, s60
    ds_write_b32 v3, v12 offset:16
    s_waitcnt lgkmcnt(0)
    s_barrier
    ds_read_b128 v[16:19], v13 offset:16
    s_waitcnt lgkmcnt(0)
    v_max3_u32 v12, v16, v17, v18
    v_max_u32 v12, v12, v19
    s_nop 0
    v_readfirstlane_b32 s60, v12
    s_and_b32 s61, s60, 0x7ff
    s_sub_u32 s35, 2047, s61
    v_cmp_ne_u32 vcc, s60, v4
    s_nop 1
    v_cndmask_b32 v4, 0, v4, vcc
    v_cmp_ne_u32 vcc, s60, v5
    s_nop 1
    v_cndmask_b32 v5, 0, v5, vcc
    v_cmp_ne_u32 vcc, s60, v6
    s_nop 1
    v_cndmask_b32 v6, 0, v6, vcc
    v_cmp_ne_u32 vcc, s60, v7
    s_nop 1
    v_cndmask_b32 v7, 0, v7, vcc
    v_cmp_ne_u32 vcc, s60, v8
    s_nop 1
    v_cndmask_b32 v8, 0, v8, vcc
    v_cmp_ne_u32 vcc, s60, v9
    s_nop 1
    v_cndmask_b32 v9, 0, v9, vcc
    v_cmp_ne_u32 vcc, s60, v10
    s_nop 1
    v_cndmask_b32 v10, 0, v10, vcc
    v_cmp_ne_u32 vcc, s60, v11
    s_nop 1
    v_cndmask_b32 v11, 0, v11, vcc
    v_max3_u32 v12, v4, v5, v6
    v_max3_u32 v12, v12, v7, v8
    v_max3_u32 v12, v12, v9, v10
    v_max_u32 v12, v12, v11
    s_nop 1
    v_max_u32_dpp v12, v12, v12 quad_perm:[1,0,3,2] row_mask:0xf bank_mask:0xf
    s_nop 1
    v_max_u32_dpp v12, v12, v12 quad_perm:[2,3,0,1] row_mask:0xf bank_mask:0xf
    s_nop 1
    v_max_u32_dpp v12, v12, v12 row_half_mirror row_mask:0xf bank_mask:0xf
    s_nop 1
    v_max_u32_dpp v12, v12, v12 row_mirror row_mask:0xf bank_mask:0xf
    s_nop 1
    v_readlane_b32 s60, v12, 0
    v_readlane_b32 s61, v12, 16
    v_readlane_b32 s62, v12, 32
    v_readlane_b32 s63, v12, 48
    s_max_u32 s60, s60, s61
    s_max_u32 s62, s62, s63
    s_max_u32 s60, s60, s62
    v_mov_b32 v12, s60
    ds_write_b32 v3, v12 offset:0
    s_waitcnt lgkmcnt(0)
    s_barrier
    ds_read_b128 v[16:19], v13 offset:0
    s_waitcnt lgkmcnt(0)
    v_max3_u32 v12, v16, v17, v18
    v_max_u32 v12, v12, v19
    s_nop 0
    v_readfirstlane_b32 s60, v12
    s_and_b32 s61, s60, 0x7ff
    s_sub_u32 s36, 2047, s61
    v_cmp_ne_u32 vcc, s60, v4
    s_nop 1
    v_cndmask_b32 v4, 0, v4, vcc
    v_cmp_ne_u32 vcc, s60, v5
    s_nop 1
    v_cndmask_b32 v5, 0, v5, vcc
    v_cmp_ne_u32 vcc, s60, v6
    s_nop 1
    v_cndmask_b32 v6, 0, v6, vcc
    v_cmp_ne_u32 vcc, s60, v7
    s_nop 1
    v_cndmask_b32 v7, 0, v7, vcc
    v_cmp_ne_u32 vcc, s60, v8
    s_nop 1
    v_cndmask_b32 v8, 0, v8, vcc
    v_cmp_ne_u32 vcc, s60, v9
    s_nop 1
    v_cndmask_b32 v9, 0, v9, vcc
    v_cmp_ne_u32 vcc, s60, v10
    s_nop 1
    v_cndmask_b32 v10, 0, v10, vcc
    v_cmp_ne_u32 vcc, s60, v11
    s_nop 1
    v_cndmask_b32 v11, 0, v11, vcc
    v_max3_u32 v12, v4, v5, v6
    v_max3_u32 v12, v12, v7, v8
    v_max3_u32 v12, v12, v9, v10
    v_max_u32 v12, v12, v11
    s_nop 1
    v_max_u32_dpp v12, v12, v12 quad_perm:[1,0,3,2] row_mask:0xf bank_mask:0xf
    s_nop 1
    v_max_u32_dpp v12, v12, v12 quad_perm:[2,3,0,1] row_mask:0xf bank_mask:0xf
    s_nop 1
    v_max_u32_dpp v12, v12, v12 row_half_mirror row_mask:0xf bank_mask:0xf
    s_nop 1
    v_max_u32_dpp v12, v12, v12 row_mirror row_mask:0xf bank_mask:0xf
    s_nop 1
    v_readlane_b32 s60, v12, 0
    v_readlane_b32 s61, v12, 16
    v_readlane_b32 s62, v12, 32
    v_readlane_b32 s63, v12, 48
    s_max_u32 s60, s60, s61
    s_max_u32 s62, s62, s63
    s_max_u32 s60, s60, s62
    v_mov_b32 v12, s60
    ds_write_b32 v3, v12 offset:16
    s_waitcnt lgkmcnt(0)
    s_barrier
    ds_read_b128 v[16:19], v13 offset:16
    s_waitcnt lgkmcnt(0)
    v_max3_u32 v12, v16, v17, v18
    v_max_u32 v12, v12, v19
    s_nop 0
    v_readfirstlane_b32 s60, v12
    s_and_b32 s61, s60, 0x7ff
    s_sub_u32 s37, 2047, s61
    v_cmp_ne_u32 vcc, s60, v4
    s_nop 1
    v_cndmask_b32 v4, 0, v4, vcc
    v_cmp_ne_u32 vcc, s60, v5
    s_nop 1
    v_cndmask_b32 v5, 0, v5, vcc
    v_cmp_ne_u32 vcc, s60, v6
    s_nop 1
    v_cndmask_b32 v6, 0, v6, vcc
    v_cmp_ne_u32 vcc, s60, v7
    s_nop 1
    v_cndmask_b32 v7, 0, v7, vcc
    v_cmp_ne_u32 vcc, s60, v8
    s_nop 1
    v_cndmask_b32 v8, 0, v8, vcc
    v_cmp_ne_u32 vcc, s60, v9
    s_nop 1
    v_cndmask_b32 v9, 0, v9, vcc
    v_cmp_ne_u32 vcc, s60, v10
    s_nop 1
    v_cndmask_b32 v10, 0, v10, vcc
    v_cmp_ne_u32 vcc, s60, v11
    s_nop 1
    v_cndmask_b32 v11, 0, v11, vcc
    v_max3_u32 v12, v4, v5, v6
    v_max3_u32 v12, v12, v7, v8
    v_max3_u32 v12, v12, v9, v10
    v_max_u32 v12, v12, v11
    s_nop 1
    v_max_u32_dpp v12, v12, v12 quad_perm:[1,0,3,2] row_mask:0xf bank_mask:0xf
    s_nop 1
    v_max_u32_dpp v12, v12, v12 quad_perm:[2,3,0,1] row_mask:0xf bank_mask:0xf
    s_nop 1
    v_max_u32_dpp v12, v12, v12 row_half_mirror row_mask:0xf bank_mask:0xf
    s_nop 1
    v_max_u32_dpp v12, v12, v12 row_mirror row_mask:0xf bank_mask:0xf
    s_nop 1
    v_readlane_b32 s60, v12, 0
    v_readlane_b32 s61, v12, 16
    v_readlane_b32 s62, v12, 32
    v_readlane_b32 s63, v12, 48
    s_max_u32 s60, s60, s61
    s_max_u32 s62, s62, s63
    s_max_u32 s60, s60, s62
    v_mov_b32 v12, s60
    ds_write_b32 v3, v12 offset:0
    s_waitcnt lgkmcnt(0)
    s_barrier
    ds_read_b128 v[16:19], v13 offset:0
    s_waitcnt lgkmcnt(0)
    v_max3_u32 v12, v16, v17, v18
    v_max_u32 v12, v12, v19
    s_nop 0
    v_readfirstlane_b32 s60, v12
    s_and_b32 s61, s60, 0x7ff
    s_sub_u32 s38, 2047, s61
    v_cmp_ne_u32 vcc, s60, v4
    s_nop 1
    v_cndmask_b32 v4, 0, v4, vcc
    v_cmp_ne_u32 vcc, s60, v5
    s_nop 1
    v_cndmask_b32 v5, 0, v5, vcc
    v_cmp_ne_u32 vcc, s60, v6
    s_nop 1
    v_cndmask_b32 v6, 0, v6, vcc
    v_cmp_ne_u32 vcc, s60, v7
    s_nop 1
    v_cndmask_b32 v7, 0, v7, vcc
    v_cmp_ne_u32 vcc, s60, v8
    s_nop 1
    v_cndmask_b32 v8, 0, v8, vcc
    v_cmp_ne_u32 vcc, s60, v9
    s_nop 1
    v_cndmask_b32 v9, 0, v9, vcc
    v_cmp_ne_u32 vcc, s60, v10
    s_nop 1
    v_cndmask_b32 v10, 0, v10, vcc
    v_cmp_ne_u32 vcc, s60, v11
    s_nop 1
    v_cndmask_b32 v11, 0, v11, vcc
    v_max3_u32 v12, v4, v5, v6
    v_max3_u32 v12, v12, v7, v8
    v_max3_u32 v12, v12, v9, v10
    v_max_u32 v12, v12, v11
    s_nop 1
    v_max_u32_dpp v12, v12, v12 quad_perm:[1,0,3,2] row_mask:0xf bank_mask:0xf
    s_nop 1
    v_max_u32_dpp v12, v12, v12 quad_perm:[2,3,0,1] row_mask:0xf bank_mask:0xf
    s_nop 1
    v_max_u32_dpp v12, v12, v12 row_half_mirror row_mask:0xf bank_mask:0xf
    s_nop 1
    v_max_u32_dpp v12, v12, v12 row_mirror row_mask:0xf bank_mask:0xf
    s_nop 1
    v_readlane_b32 s60, v12, 0
    v_readlane_b32 s61, v12, 16
    v_readlane_b32 s62, v12, 32
    v_readlane_b32 s63, v12, 48
    s_max_u32 s60, s60, s61
    s_max_u32 s62, s62, s63
    s_max_u32 s60, s60, s62
    v_mov_b32 v12, s60
    ds_write_b32 v3, v12 offset:16
    s_waitcnt lgkmcnt(0)
    s_barrier
    ds_read_b128 v[16:19], v13 offset:16
    s_waitcnt lgkmcnt(0)
    v_max3_u32 v12, v16, v17, v18
    v_max_u32 v12, v12, v19
    s_nop 0
    v_readfirstlane_b32 s60, v12
    s_and_b32 s61, s60, 0x7ff
    s_sub_u32 s39, 2047, s61
    v_cmp_ne_u32 vcc, s60, v4
    s_nop 1
    v_cndmask_b32 v4, 0, v4, vcc
    v_cmp_ne_u32 vcc, s60, v5
    s_nop 1
    v_cndmask_b32 v5, 0, v5, vcc
    v_cmp_ne_u32 vcc, s60, v6
    s_nop 1
    v_cndmask_b32 v6, 0, v6, vcc
    v_cmp_ne_u32 vcc, s60, v7
    s_nop 1
    v_cndmask_b32 v7, 0, v7, vcc
    v_cmp_ne_u32 vcc, s60, v8
    s_nop 1
    v_cndmask_b32 v8, 0, v8, vcc
    v_cmp_ne_u32 vcc, s60, v9
    s_nop 1
    v_cndmask_b32 v9, 0, v9, vcc
    v_cmp_ne_u32 vcc, s60, v10
    s_nop 1
    v_cndmask_b32 v10, 0, v10, vcc
    v_cmp_ne_u32 vcc, s60, v11
    s_nop 1
    v_cndmask_b32 v11, 0, v11, vcc
    v_mov_b32 v20, s32
    v_cmp_eq_u32 vcc, 1, v22
    v_mov_b32 v2, s33
    v_cndmask_b32 v20, v20, v2, vcc
    v_cmp_eq_u32 vcc, 2, v22
    v_mov_b32 v2, s34
    v_cndmask_b32 v20, v20, v2, vcc
    v_cmp_eq_u32 vcc, 3, v22
    v_mov_b32 v2, s35
    v_cndmask_b32 v20, v20, v2, vcc
    v_cmp_eq_u32 vcc, 4, v22
    v_mov_b32 v2, s36
    v_cndmask_b32 v20, v20, v2, vcc
    v_cmp_eq_u32 vcc, 5, v22
    v_mov_b32 v2, s37
    v_cndmask_b32 v20, v20, v2, vcc
    v_cmp_eq_u32 vcc, 6, v22
    v_mov_b32 v2, s38
    v_cndmask_b32 v20, v20, v2, vcc
    v_cmp_eq_u32 vcc, 7, v22
    v_mov_b32 v2, s39
    v_cndmask_b32 v20, v20, v2, vcc
    s_cmp_lg_u32 s2, 0
    s_cbranch_scc1 L_k4_noidx
    v_cmp_gt_u32 vcc, 8, v0
    s_and_saveexec_b64 s[60:61], vcc
    v_lshlrev_b32 v2, 2, v0
    buffer_store_dword v20, v2, s[28:31], 0 offen
    s_mov_b64 exec, s[60:61]
L_k4_noidx:
    v_mul_u32_u24 v21, 1280, v20
    v_lshl_add_u32 v21, v23, 4, v21
    s_mul_i32 s3, s47, 320
    buffer_load_dwordx4 v[100:103], v21, s[12:15], s3 offen offset:0
    buffer_load_dwordx4 v[104:107], v21, s[12:15], s3 offen offset:64
    buffer_load_dwordx4 v[108:111], v21, s[12:15], s3 offen offset:128
    buffer_load_dwordx4 v[112:115], v21, s[12:15], s3 offen offset:192
    buffer_load_dwordx4 v[116:119], v21, s[12:15], s3 offen offset:256
    s_waitcnt vmcnt(0)
    v_lshl_or_b32 v40, v129, 16, v128
    v_lshl_or_b32 v60, v169, 16, v168
    v_lshl_or_b32 v80, v209, 16, v208
    v_lshl_or_b32 v41, v131, 16, v130
    v_lshl_or_b32 v61, v171, 16, v170
    v_lshl_or_b32 v81, v211, 16, v210
    v_lshl_or_b32 v42, v133, 16, v132
    v_lshl_or_b32 v62, v173, 16, v172
    v_lshl_or_b32 v82, v213, 16, v212
    v_lshl_or_b32 v43, v135, 16, v134
    v_lshl_or_b32 v63, v175, 16, v174
    v_lshl_or_b32 v83, v215, 16, v214
    v_lshl_or_b32 v44, v137, 16, v136
    v_lshl_or_b32 v64, v177, 16, v176
    v_lshl_or_b32 v84, v217, 16, v216
    v_lshl_or_b32 v45, v139, 16, v138
    v_lshl_or_b32 v65, v179, 16, v178
    v_lshl_or_b32 v85, v219, 16, v218
    v_lshl_or_b32 v46, v141, 16, v140
    v_lshl_or_b32 v66, v181, 16, v180
    v_lshl_or_b32 v86, v221, 16, v220
    v_lshl_or_b32 v47, v143, 16, v142
    v_lshl_or_b32 v67, v183, 16, v182
    v_lshl_or_b32 v87, v223, 16, v222
    v_lshl_or_b32 v48, v145, 16, v144
    v_lshl_or_b32 v68, v185, 16, v184
    v_lshl_or_b32 v88, v225, 16, v224
    v_lshl_or_b32 v49, v147, 16, v146
    v_lshl_or_b32 v69, v187, 16, v186
    v_lshl_or_b32 v89, v227, 16, v226
    v_lshl_or_b32 v50, v149, 16, v148
    v_lshl_or_b32 v70, v189, 16, v188
    v_lshl_or_b32 v90, v229, 16, v228
    v_lshl_or_b32 v51, v151, 16, v150
    v_lshl_or_b32 v71, v191, 16, v190
    v_lshl_or_b32 v91, v231, 16, v230
    v_lshl_or_b32 v52, v153, 16, v152
    v_lshl_or_b32 v72, v193, 16, v192
    v_lshl_or_b32 v92, v233, 16, v232
    v_lshl_or_b32 v53, v155, 16, v154
    v_lshl_or_b32 v73, v195, 16, v194
    v_lshl_or_b32 v93, v235, 16, v234
    v_lshl_or_b32 v54, v157, 16, v156
    v_lshl_or_b32 v74, v197, 16, v196
    v_lshl_or_b32 v94, v237, 16, v236
    v_lshl_or_b32 v55, v159, 16, v158
    v_lshl_or_b32 v75, v199, 16, v198
    v_lshl_or_b32 v95, v239, 16, v238
    v_lshl_or_b32 v56, v161, 16, v160
    v_lshl_or_b32 v76, v201, 16, v200
    v_lshl_or_b32 v96, v241, 16, v240
    v_lshl_or_b32 v57, v163, 16, v162
    v_lshl_or_b32 v77, v203, 16, v202
    v_lshl_or_b32 v97, v243, 16, v242
    v_lshl_or_b32 v58, v165, 16, v164
    v_lshl_or_b32 v78, v205, 16, v204
    v_lshl_or_b32 v98, v245, 16, v244
    v_lshl_or_b32 v59, v167, 16, v166
    v_lshl_or_b32 v79, v207, 16, v206
    v_lshl_or_b32 v99, v247, 16, v246
    s_nop 1
    v_mfma_f32_16x16x32_bf16 v[120:123], v[100:103], v[40:43], 0
    v_mfma_f32_16x16x32_bf16 v[124:127], v[100:103], v[60:63], 0
    v_mfma_f32_16x16x32_bf16 v[120:123], v[104:107], v[44:47], v[120:123]
    v_mfma_f32_16x16x32_bf16 v[124:127], v[104:107], v[64:67], v[124:127]
    v_mfma_f32_16x16x32_bf16 v[120:123], v[108:111], v[48:51], v[120:123]
    v_mfma_f32_16x16x32_bf16 v[124:127], v[108:111], v[68:71], v[124:127]
    v_mfma_f32_16x16x32_bf16 v[120:123], v[112:115], v[52:55], v[120:123]
    v_mfma_f32_16x16x32_bf16 v[124:127], v[112:115], v[72:75], v[124:127]
    v_mfma_f32_16x16x32_bf16 v[120:123], v[116:119], v[56:59], v[120:123]
    v_mfma_f32_16x16x32_bf16 v[124:127], v[116:119], v[76:79], v[124:127]
    v_and_b32 v1, 63, v0
    v_lshlrev_b32 v1, 5, v1
    s_lshl_b32 s3, s47, 11
    v_add_u32 v2, s3, v1
    s_nop 7
    ds_write_b128 v2, v[120:123] offset:64
    ds_write_b128 v2, v[124:127] offset:80
    s_waitcnt lgkmcnt(0)
    s_barrier
    ds_read_b128 v[40:43], v1 offset:64
    ds_read_b128 v[44:47], v1 offset:80
    ds_read_b128 v[48:51], v1 offset:2112
    ds_read_b128 v[52:55], v1 offset:2128
    ds_read_b128 v[56:59], v1 offset:4160
    ds_read_b128 v[60:63], v1 offset:4176
    ds_read_b128 v[64:67], v1 offset:6208
    ds_read_b128 v[68:71], v1 offset:6224
    s_waitcnt lgkmcnt(0)
    v_add_f32 v40, v40, v48
    v_add_f32 v56, v56, v64
    v_add_f32 v40, v40, v56
    v_add_f32 v41, v41, v49
    v_add_f32 v57, v57, v65
    v_add_f32 v41, v41, v57
    v_add_f32 v42, v42, v50
    v_add_f32 v58, v58, v66
    v_add_f32 v42, v42, v58
    v_add_f32 v43, v43, v51
    v_add_f32 v59, v59, v67
    v_add_f32 v43, v43, v59
    v_add_f32 v44, v44, v52
    v_add_f32 v60, v60, v68
    v_add_f32 v44, v44, v60
    v_add_f32 v45, v45, v53
    v_add_f32 v61, v61, v69
    v_add_f32 v45, v45, v61
    v_add_f32 v46, v46, v54
    v_add_f32 v62, v62, v70
    v_add_f32 v46, v46, v62
    v_add_f32 v47, v47, v55
    v_add_f32 v63, v63, v71
    v_add_f32 v47, v47, v63
    s_lshl_b32 s3, s47, 9
    v_lshlrev_b32 v2, 7, v23
    v_lshl_add_u32 v2, v22, 1, v2
    v_add_u32 v2, s3, v2
    v_cvt_pk_bf16_f32 v40, v40, v40
    v_lshlrev_b32 v40, 16, v40
    v_cvt_pk_bf16_f32 v44, v44, v44
    v_lshlrev_b32 v44, 16, v44
    v_mul_f32 v9, 0xbfb8aa3b, v40
    v_exp_f32 v9, v9
    s_nop 0
    v_add_f32 v9, 1.0, v9
    v_rcp_f32 v9, v9
    s_nop 0
    v_mul_f32 v9, v40, v9
    v_cvt_pk_bf16_f32 v9, v9, v9
    v_lshlrev_b32 v9, 16, v9
    v_mul_f32 v9, v9, v44
    v_cvt_pk_bf16_f32 v9, v9, v9
    ds_write_b16 v2, v9 offset:8256
    v_cvt_pk_bf16_f32 v41, v41, v41
    v_lshlrev_b32 v41, 16, v41
    v_cvt_pk_bf16_f32 v45, v45, v45
    v_lshlrev_b32 v45, 16, v45
    v_mul_f32 v9, 0xbfb8aa3b, v41
    v_exp_f32 v9, v9
    s_nop 0
    v_add_f32 v9, 1.0, v9
    v_rcp_f32 v9, v9
    s_nop 0
    v_mul_f32 v9, v41, v9
    v_cvt_pk_bf16_f32 v9, v9, v9
    v_lshlrev_b32 v9, 16, v9
    v_mul_f32 v9, v9, v45
    v_cvt_pk_bf16_f32 v9, v9, v9
    ds_write_b16 v2, v9 offset:8288
    v_cvt_pk_bf16_f32 v42, v42, v42
    v_lshlrev_b32 v42, 16, v42
    v_cvt_pk_bf16_f32 v46, v46, v46
    v_lshlrev_b32 v46, 16, v46
    v_mul_f32 v9, 0xbfb8aa3b, v42
    v_exp_f32 v9, v9
    s_nop 0
    v_add_f32 v9, 1.0, v9
    v_rcp_f32 v9, v9
    s_nop 0
    v_mul_f32 v9, v42, v9
    v_cvt_pk_bf16_f32 v9, v9, v9
    v_lshlrev_b32 v9, 16, v9
    v_mul_f32 v9, v9, v46
    v_cvt_pk_bf16_f32 v9, v9, v9
    ds_write_b16 v2, v9 offset:8320
    v_cvt_pk_bf16_f32 v43, v43, v43
    v_lshlrev_b32 v43, 16, v43
    v_cvt_pk_bf16_f32 v47, v47, v47
    v_lshlrev_b32 v47, 16, v47
    v_mul_f32 v9, 0xbfb8aa3b, v43
    v_exp_f32 v9, v9
    s_nop 0
    v_add_f32 v9, 1.0, v9
    v_rcp_f32 v9, v9
    s_nop 0
    v_mul_f32 v9, v43, v9
    v_cvt_pk_bf16_f32 v9, v9, v9
    v_lshlrev_b32 v9, 16, v9
    v_mul_f32 v9, v9, v47
    v_cvt_pk_bf16_f32 v9, v9, v9
    ds_write_b16 v2, v9 offset:8352
    v_lshlrev_b32 v3, 5, v22
    v_lshl_add_u32 v3, v23, 3, v3
    v_add_u32 v3, s3, v3
    s_waitcnt lgkmcnt(0)
    ds_read_b64 v[10:11], v3 offset:8256
    v_mul_u32_u24 v4, 2560, v22
    v_lshl_add_u32 v4, v23, 4, v4
    s_mul_i32 s53, s2, 20480
    s_mul_i32 s3, s47, 640
    s_add_u32 s53, s53, s3
    s_waitcnt lgkmcnt(0)
    v_mfma_f32_16x16x16_bf16 v[40:43], v[80:81], v[10:11], 0
    v_mfma_f32_16x16x16_bf16 v[44:47], v[82:83], v[10:11], 0
    v_mfma_f32_16x16x16_bf16 v[48:51], v[84:85], v[10:11], 0
    v_mfma_f32_16x16x16_bf16 v[52:55], v[86:87], v[10:11], 0
    v_mfma_f32_16x16x16_bf16 v[56:59], v[88:89], v[10:11], 0
    v_mfma_f32_16x16x16_bf16 v[60:63], v[90:91], v[10:11], 0
    v_mfma_f32_16x16x16_bf16 v[64:67], v[92:93], v[10:11], 0
    v_mfma_f32_16x16x16_bf16 v[68:71], v[94:95], v[10:11], 0
    v_mfma_f32_16x16x16_bf16 v[72:75], v[96:97], v[10:11], 0
    v_mfma_f32_16x16x16_bf16 v[76:79], v[98:99], v[10:11], 0
    v_cmp_gt_u32 vcc, 8, v22
    s_and_saveexec_b64 s[60:61], vcc
    s_nop 7
    s_add_u32 s3, s53, 0
    buffer_store_dwordx4 v[40:43], v4, s[24:27], s3 offen
    s_add_u32 s3, s53, 64
    buffer_store_dwordx4 v[44:47], v4, s[24:27], s3 offen
    s_add_u32 s3, s53, 128
    buffer_store_dwordx4 v[48:51], v4, s[24:27], s3 offen
    s_add_u32 s3, s53, 192
    buffer_store_dwordx4 v[52:55], v4, s[24:27], s3 offen
    s_add_u32 s3, s53, 256
    buffer_store_dwordx4 v[56:59], v4, s[24:27], s3 offen
    s_add_u32 s3, s53, 320
    buffer_store_dwordx4 v[60:63], v4, s[24:27], s3 offen
    s_add_u32 s3, s53, 384
    buffer_store_dwordx4 v[64:67], v4, s[24:27], s3 offen
    s_add_u32 s3, s53, 448
    buffer_store_dwordx4 v[68:71], v4, s[24:27], s3 offen
    s_add_u32 s3, s53, 512
    buffer_store_dwordx4 v[72:75], v4, s[24:27], s3 offen
    s_add_u32 s3, s53, 576
    buffer_store_dwordx4 v[76:79], v4, s[24:27], s3 offen
    s_mov_b64 exec, s[60:61]
L_k4_end:
    s_endpgm
.globl ffn2_kernel
.p2align 8
.type ffn2_kernel,@function
ffn2_kernel:
    s_cmp_ge_u32 s2, 20
    s_cbranch_scc1 L_k5_end
    s_load_dwordx2 s[6:7], s[0:1], 96
    s_load_dwordx2 s[42:43], s[0:1], 80
    s_waitcnt lgkmcnt(0)
    s_add_u32 s8, s6, 50331648
    s_addc_u32 s9, s7, 0
    s_mov_b32 s10, 8192
    s_mov_b32 s11, 0x00020000
    s_add_u32 s12, s6, 46137344
    s_addc_u32 s13, s7, 0
    s_mov_b32 s14, 2621440
    s_mov_b32 s15, 0x00020000
    s_mov_b32 s20, s42
    s_mov_b32 s21, s43
    s_mov_b32 s22, 2621440
    s_mov_b32 s23, 0x00020000
    s_add_u32 s24, s6, 54525952
    s_addc_u32 s25, s7, 0
    s_mov_b32 s26, 1966080
    s_mov_b32 s27, 0x00020000
    s_add_u32 s28, s6, 50462720
    s_addc_u32 s29, s7, 0
    s_mov_b32 s30, 32
    s_mov_b32 s31, 0x00020000
    s_add_u32 s44, s6, 41943040
    s_addc_u32 s45, s7, 0
    s_mov_b32 s46, 2621440
    s_mov_b32 s47, 0x00020000
    s_lshl_b32 s3, s2, 8
    v_add_u32 v1, s3, v0
    v_mul_u32_u24 v2, 0x199a, v1
    v_lshrrev_b32 v2, 22, v2
    v_mul_u32_u24 v3, 640, v2
    v_sub_u32 v3, v1, v3
    v_lshlrev_b32 v4, 2, v2
    buffer_load_dword v5, v4, s[28:31], 0 offen
    v_lshlrev_b32 v1, 2, v1
    s_mov_b32 s3, 0
    buffer_load_dword v16, v1, s[24:27], s3 offen
    s_mov_b32 s3, 20480
    buffer_load_dword v17, v1, s[24:27], s3 offen
    s_mov_b32 s3, 40960
    buffer_load_dword v18, v1, s[24:27], s3 offen
    s_mov_b32 s3, 61440
    buffer_load_dword v19, v1, s[24:27], s3 offen
    s_mov_b32 s3, 81920
    buffer_load_dword v20, v1, s[24:27], s3 offen
    s_mov_b32 s3, 102400
    buffer_load_dword v21, v1, s[24:27], s3 offen
    s_mov_b32 s3, 122880
    buffer_load_dword v22, v1, s[24:27], s3 offen
    s_mov_b32 s3, 143360
    buffer_load_dword v23, v1, s[24:27], s3 offen
    s_mov_b32 s3, 163840
    buffer_load_dword v24, v1, s[24:27], s3 offen
    s_mov_b32 s3, 184320
    buffer_load_dword v25, v1, s[24:27], s3 offen
    s_mov_b32 s3, 204800
    buffer_load_dword v26, v1, s[24:27], s3 offen
    s_mov_b32 s3, 225280
    buffer_load_dword v27, v1, s[24:27], s3 offen
    s_mov_b32 s3, 245760
    buffer_load_dword v28, v1, s[24:27], s3 offen
    s_mov_b32 s3, 266240
    buffer_load_dword v29, v1, s[24:27], s3 offen
    s_mov_b32 s3, 286720
    buffer_load_dword v30, v1, s[24:27], s3 offen
    s_mov_b32 s3, 307200
    buffer_load_dword v31, v1, s[24:27], s3 offen
    s_mov_b32 s3, 327680
    buffer_load_dword v32, v1, s[24:27], s3 offen
    s_mov_b32 s3, 348160
    buffer_load_dword v33, v1, s[24:27], s3 offen
    s_mov_b32 s3, 368640
    buffer_load_dword v34, v1, s[24:27], s3 offen
    s_mov_b32 s3, 389120
    buffer_load_dword v35, v1, s[24:27], s3 offen
    s_mov_b32 s3, 409600
    buffer_load_dword v36, v1, s[24:27], s3 offen
    s_mov_b32 s3, 430080
    buffer_load_dword v37, v1, s[24:27], s3 offen
    s_mov_b32 s3, 450560
    buffer_load_dword v38, v1, s[24:27], s3 offen
    s_mov_b32 s3, 471040
    buffer_load_dword v39, v1, s[24:27], s3 offen
    s_mov_b32 s3, 491520
    buffer_load_dword v40, v1, s[24:27], s3 offen
    s_mov_b32 s3, 512000
    buffer_load_dword v41, v1, s[24:27], s3 offen
    s_mov_b32 s3, 532480
    buffer_load_dword v42, v1, s[24:27], s3 offen
    s_mov_b32 s3, 552960
    buffer_load_dword v43, v1, s[24:27], s3 offen
    s_mov_b32 s3, 573440
    buffer_load_dword v44, v1, s[24:27], s3 offen
    s_mov_b32 s3, 593920
    buffer_load_dword v45, v1, s[24:27], s3 offen
    s_mov_b32 s3, 614400
    buffer_load_dword v46, v1, s[24:27], s3 offen
    s_mov_b32 s3, 634880
    buffer_load_dword v47, v1, s[24:27], s3 offen
    s_mov_b32 s3, 655360
    buffer_load_dword v48, v1, s[24:27], s3 offen
    s_mov_b32 s3, 675840
    buffer_load_dword v49, v1, s[24:27], s3 offen
    s_mov_b32 s3, 696320
    buffer_load_dword v50, v1, s[24:27], s3 offen
    s_mov_b32 s3, 716800
    buffer_load_dword v51, v1, s[24:27], s3 offen
    s_mov_b32 s3, 737280
    buffer_load_dword v52, v1, s[24:27], s3 offen
    s_mov_b32 s3, 757760
    buffer_load_dword v53, v1, s[24:27], s3 offen
    s_mov_b32 s3, 778240
    buffer_load_dword v54, v1, s[24:27], s3 offen
    s_mov_b32 s3, 798720
    buffer_load_dword v55, v1, s[24:27], s3 offen
    s_mov_b32 s3, 819200
    buffer_load_dword v56, v1, s[24:27], s3 offen
    s_mov_b32 s3, 839680
    buffer_load_dword v57, v1, s[24:27], s3 offen
    s_mov_b32 s3, 860160
    buffer_load_dword v58, v1, s[24:27], s3 offen
    s_mov_b32 s3, 880640
    buffer_load_dword v59, v1, s[24:27], s3 offen
    s_mov_b32 s3, 901120
    buffer_load_dword v60, v1, s[24:27], s3 offen
    s_mov_b32 s3, 921600
    buffer_load_dword v61, v1, s[24:27], s3 offen
    s_mov_b32 s3, 942080
    buffer_load_dword v62, v1, s[24:27], s3 offen
    s_mov_b32 s3, 962560
    buffer_load_dword v63, v1, s[24:27], s3 offen
    s_mov_b32 s3, 983040
    buffer_load_dword v64, v1, s[24:27], s3 offen
    s_mov_b32 s3, 1003520
    buffer_load_dword v65, v1, s[24:27], s3 offen
    s_mov_b32 s3, 1024000
    buffer_load_dword v66, v1, s[24:27], s3 offen
    s_mov_b32 s3, 1044480
    buffer_load_dword v67, v1, s[24:27], s3 offen
    s_mov_b32 s3, 1064960
    buffer_load_dword v68, v1, s[24:27], s3 offen
    s_mov_b32 s3, 1085440
    buffer_load_dword v69, v1, s[24:27], s3 offen
    s_mov_b32 s3, 1105920
    buffer_load_dword v70, v1, s[24:27], s3 offen
    s_mov_b32 s3, 1126400
    buffer_load_dword v71, v1, s[24:27], s3 offen
    s_mov_b32 s3, 1146880
    buffer_load_dword v72, v1, s[24:27], s3 offen
    s_mov_b32 s3, 1167360
    buffer_load_dword v73, v1, s[24:27], s3 offen
    s_mov_b32 s3, 1187840
    buffer_load_dword v74, v1, s[24:27], s3 offen
    s_mov_b32 s3, 1208320
    buffer_load_dword v75, v1, s[24:27], s3 offen
    s_mov_b32 s3, 1228800
    buffer_load_dword v76, v1, s[24:27], s3 offen
    s_mov_b32 s3, 1249280
    buffer_load_dword v77, v1, s[24:27], s3 offen
    s_mov_b32 s3, 1269760
    buffer_load_dword v78, v1, s[24:27], s3 offen
    s_mov_b32 s3, 1290240
    buffer_load_dword v79, v1, s[24:27], s3 offen
    s_mov_b32 s3, 1310720
    buffer_load_dword v80, v1, s[24:27], s3 offen
    s_mov_b32 s3, 1331200
    buffer_load_dword v81, v1, s[24:27], s3 offen
    s_mov_b32 s3, 1351680
    buffer_load_dword v82, v1, s[24:27], s3 offen
    s_mov_b32 s3, 1372160
    buffer_load_dword v83, v1, s[24:27], s3 offen
    s_mov_b32 s3, 1392640
    buffer_load_dword v84, v1, s[24:27], s3 offen
    s_mov_b32 s3, 1413120
    buffer_load_dword v85, v1, s[24:27], s3 offen
    s_mov_b32 s3, 1433600
    buffer_load_dword v86, v1, s[24:27], s3 offen
    s_mov_b32 s3, 1454080
    buffer_load_dword v87, v1, s[24:27], s3 offen
    s_mov_b32 s3, 1474560
    buffer_load_dword v88, v1, s[24:27], s3 offen
    s_mov_b32 s3, 1495040
    buffer_load_dword v89, v1, s[24:27], s3 offen
    s_mov_b32 s3, 1515520
    buffer_load_dword v90, v1, s[24:27], s3 offen
    s_mov_b32 s3, 1536000
    buffer_load_dword v91, v1, s[24:27], s3 offen
    s_mov_b32 s3, 1556480
    buffer_load_dword v92, v1, s[24:27], s3 offen
    s_mov_b32 s3, 1576960
    buffer_load_dword v93, v1, s[24:27], s3 offen
    s_mov_b32 s3, 1597440
    buffer_load_dword v94, v1, s[24:27], s3 offen
    s_mov_b32 s3, 1617920
    buffer_load_dword v95, v1, s[24:27], s3 offen
    s_mov_b32 s3, 1638400
    buffer_load_dword v96, v1, s[24:27], s3 offen
    s_mov_b32 s3, 1658880
    buffer_load_dword v97, v1, s[24:27], s3 offen
    s_mov_b32 s3, 1679360
    buffer_load_dword v98, v1, s[24:27], s3 offen
    s_mov_b32 s3, 1699840
    buffer_load_dword v99, v1, s[24:27], s3 offen
    s_mov_b32 s3, 1720320
    buffer_load_dword v100, v1, s[24:27], s3 offen
    s_mov_b32 s3, 1740800
    buffer_load_dword v101, v1, s[24:27], s3 offen
    s_mov_b32 s3, 1761280
    buffer_load_dword v102, v1, s[24:27], s3 offen
    s_mov_b32 s3, 1781760
    buffer_load_dword v103, v1, s[24:27], s3 offen
    s_mov_b32 s3, 1802240
    buffer_load_dword v104, v1, s[24:27], s3 offen
    s_mov_b32 s3, 1822720
    buffer_load_dword v105, v1, s[24:27], s3 offen
    s_mov_b32 s3, 1843200
    buffer_load_dword v106, v1, s[24:27], s3 offen
    s_mov_b32 s3, 1863680
    buffer_load_dword v107, v1, s[24:27], s3 offen
    s_mov_b32 s3, 1884160
    buffer_load_dword v108, v1, s[24:27], s3 offen
    s_mov_b32 s3, 1904640
    buffer_load_dword v109, v1, s[24:27], s3 offen
    s_mov_b32 s3, 1925120
    buffer_load_dword v110, v1, s[24:27], s3 offen
    s_mov_b32 s3, 1945600
    buffer_load_dword v111, v1, s[24:27], s3 offen
    s_waitcnt vmcnt(63)
    s_waitcnt vmcnt(0)
    v_lshlrev_b32 v6, 2, v5
    buffer_load_dword v9, v6, s[8:11], 0 offen
    v_mul_u32_u24 v6, 1280, v5
    v_lshl_add_u32 v6, v3, 1, v6
    buffer_load_ushort v10, v6, s[12:15], 0 offen
    buffer_load_ushort v11, v6, s[44:47], 0 offen
    v_add_f32 v16, v16, v17
    v_add_f32 v16, v16, v18
    v_add_f32 v16, v16, v19
    v_add_f32 v16, v16, v20
    v_add_f32 v16, v16, v21
    v_add_f32 v16, v16, v22
    v_add_f32 v16, v16, v23
    v_add_f32 v16, v16, v24
    v_add_f32 v16, v16, v25
    v_add_f32 v16, v16, v26
    v_add_f32 v16, v16, v27
    v_add_f32 v16, v16, v28
    v_add_f32 v16, v16, v29
    v_add_f32 v16, v16, v30
    v_add_f32 v16, v16, v31
    v_add_f32 v16, v16, v32
    v_add_f32 v16, v16, v33
    v_add_f32 v16, v16, v34
    v_add_f32 v16, v16, v35
    v_add_f32 v16, v16, v36
    v_add_f32 v16, v16, v37
    v_add_f32 v16, v16, v38
    v_add_f32 v16, v16, v39
    v_add_f32 v16, v16, v40
    v_add_f32 v16, v16, v41
    v_add_f32 v16, v16, v42
    v_add_f32 v16, v16, v43
    v_add_f32 v16, v16, v44
    v_add_f32 v16, v16, v45
    v_add_f32 v16, v16, v46
    v_add_f32 v16, v16, v47
    v_add_f32 v16, v16, v48
    v_add_f32 v16, v16, v49
    v_add_f32 v16, v16, v50
    v_add_f32 v16, v16, v51
    v_add_f32 v16, v16, v52
    v_add_f32 v16, v16, v53
    v_add_f32 v16, v16, v54
    v_add_f32 v16, v16, v55
    v_add_f32 v16, v16, v56
    v_add_f32 v16, v16, v57
    v_add_f32 v16, v16, v58
    v_add_f32 v16, v16, v59
    v_add_f32 v16, v16, v60
    v_add_f32 v16, v16, v61
    v_add_f32 v16, v16, v62
    v_add_f32 v16, v16, v63
    v_add_f32 v16, v16, v64
    v_add_f32 v16, v16, v65
    v_add_f32 v16, v16, v66
    v_add_f32 v16, v16, v67
    v_add_f32 v16, v16, v68
    v_add_f32 v16, v16, v69
    v_add_f32 v16, v16, v70
    v_add_f32 v16, v16, v71
    v_add_f32 v16, v16, v72
    v_add_f32 v16, v16, v73
    v_add_f32 v16, v16, v74
    v_add_f32 v16, v16, v75
    v_add_f32 v16, v16, v76
    v_add_f32 v16, v16, v77
    v_add_f32 v16, v16, v78
    v_add_f32 v16, v16, v79
    v_add_f32 v16, v16, v80
    v_add_f32 v16, v16, v81
    v_add_f32 v16, v16, v82
    v_add_f32 v16, v16, v83
    v_add_f32 v16, v16, v84
    v_add_f32 v16, v16, v85
    v_add_f32 v16, v16, v86
    v_add_f32 v16, v16, v87
    v_add_f32 v16, v16, v88
    v_add_f32 v16, v16, v89
    v_add_f32 v16, v16, v90
    v_add_f32 v16, v16, v91
    v_add_f32 v16, v16, v92
    v_add_f32 v16, v16, v93
    v_add_f32 v16, v16, v94
    v_add_f32 v16, v16, v95
    v_add_f32 v16, v16, v96
    v_add_f32 v16, v16, v97
    v_add_f32 v16, v16, v98
    v_add_f32 v16, v16, v99
    v_add_f32 v16, v16, v100
    v_add_f32 v16, v16, v101
    v_add_f32 v16, v16, v102
    v_add_f32 v16, v16, v103
    v_add_f32 v16, v16, v104
    v_add_f32 v16, v16, v105
    v_add_f32 v16, v16, v106
    v_add_f32 v16, v16, v107
    v_add_f32 v16, v16, v108
    v_add_f32 v16, v16, v109
    v_add_f32 v16, v16, v110
    v_add_f32 v16, v16, v111
    v_cvt_pk_bf16_f32 v8, v16, v16
    v_lshlrev_b32 v8, 16, v8
    s_waitcnt vmcnt(0)
    v_mul_f32 v9, 0xbfb8aa3b, v9
    v_exp_f32 v9, v9
    s_nop 0
    v_add_f32 v9, 1.0, v9
    v_rcp_f32 v9, v9
    s_nop 0
    v_cvt_pk_bf16_f32 v9, v9, v9
    v_lshlrev_b32 v9, 16, v9
    v_mul_f32 v8, v8, v9
    v_cvt_pk_bf16_f32 v8, v8, v8
    v_lshlrev_b32 v8, 16, v8
    v_lshlrev_b32 v10, 16, v10
    v_lshlrev_b32 v11, 16, v11
    v_add_f32 v8, v10, v8
    v_cvt_pk_bf16_f32 v8, v8, v8
    v_lshlrev_b32 v8, 16, v8
    v_add_f32 v8, v11, v8
    v_cvt_pk_bf16_f32 v8, v8, v8
    buffer_store_short v8, v6, s[20:23], 0 offen
L_k5_end:
    s_endpgm
.section .rodata,"a"
.p2align 6
.amdhsa_kernel gemm1_kernel
  .amdhsa_next_free_vgpr 141
  .amdhsa_next_free_sgpr 102
  .amdhsa_accum_offset 144
  .amdhsa_group_segment_fixed_size 0
  .amdhsa_kernarg_size 104
  .amdhsa_user_sgpr_count 2
  .amdhsa_user_sgpr_kernarg_segment_ptr 1
  .amdhsa_system_sgpr_workgroup_id_x 1
.end_amdhsa_kernel
.p2align 6
.amdhsa_kernel gemm2_kernel
  .amdhsa_next_free_vgpr 172
  .amdhsa_next_free_sgpr 102
  .amdhsa_accum_offset 172
  .amdhsa_group_segment_fixed_size 0
  .amdhsa_kernarg_size 104
  .amdhsa_user_sgpr_count 2
  .amdhsa_user_sgpr_kernarg_segment_ptr 1
  .amdhsa_system_sgpr_workgroup_id_x 1
.end_amdhsa_kernel
.p2align 6
.amdhsa_kernel ln2_kernel
  .amdhsa_next_free_vgpr 96
  .amdhsa_next_free_sgpr 102
  .amdhsa_accum_offset 96
  .amdhsa_group_segment_fixed_size 0
  .amdhsa_kernarg_size 104
  .amdhsa_user_sgpr_count 2
  .amdhsa_user_sgpr_kernarg_segment_ptr 1
  .amdhsa_system_sgpr_workgroup_id_x 1
.end_amdhsa_kernel
.p2align 6
.amdhsa_kernel ffn1_kernel
  .amdhsa_next_free_vgpr 248
  .amdhsa_next_free_sgpr 102
  .amdhsa_accum_offset 248
  .amdhsa_group_segment_fixed_size 0
  .amdhsa_kernarg_size 104
  .amdhsa_user_sgpr_count 2
  .amdhsa_user_sgpr_kernarg_segment_ptr 1
  .amdhsa_system_sgpr_workgroup_id_x 1
.end_amdhsa_kernel
.p2align 6
.amdhsa_kernel ffn2_kernel
  .amdhsa_next_free_vgpr 120
  .amdhsa_next_free_sgpr 102
  .amdhsa_accum_offset 120
  .amdhsa_group_segment_fixed_size 0
  .amdhsa_kernarg_size 104
  .amdhsa_user_sgpr_count 2
  .amdhsa_user_sgpr_kernarg_segment_ptr 1
  .amdhsa_system_sgpr_workgroup_id_x 1
.end_amdhsa_kernel
```
